```python
import torch

def _softmax(x, axis=-1):
    return torch.softmax(x, dim=axis)
def _gelu(x):
    return torch.nn.functional.gelu(x, approximate="tanh")
def _silu(x):
    return torch.nn.functional.silu(x)
def _sigmoid(x):
    return torch.sigmoid(x)
def _layernorm(x, axis=-1, eps=1e-5):
    m = x.mean(dim=axis, keepdim=True)
    v = x.var(dim=axis, keepdim=True, unbiased=False)
    return (x - m) / torch.sqrt(v + eps)
def _scatter_add(tgt, idx, src, axis=0):
    return tgt.clone().index_add_(axis, idx, src)
def _segment_sum(src, seg, n):
    out = torch.zeros((n,) + src.shape[1:], dtype=src.dtype)
    return out.index_add_(0, seg, src)
def _pad(x, pw):
    flat = tuple(v for pair in reversed(pw) for v in pair)
    return torch.nn.functional.pad(x, flat)

kernel_name = 'recurrent_scan__mha_block_cached__dense_activation_squared_relu__decode'

def setup_inputs():

    _w = (lambda a: (lambda t: t.to(torch.bfloat16) if t.is_floating_point() else t)(torch.as_tensor(a)))
    def _A_setup():
        B, Sq, D = 4, 1, 448
        H, Sk, Dh = 16, 4096, 256
        return {
            "x": _w((lambda *s: torch.randn(*s, dtype=torch.bfloat16) * 0.05)(B, Sq, D)),
            "k_cache": _w((lambda *s: torch.randn(*s, dtype=torch.bfloat16) * 0.8)(B, H, Sk, Dh)),
            "v_cache": _w((lambda *s: torch.randn(*s, dtype=torch.bfloat16) * 0.2)(B, H, Sk, Dh)),
            "wq": _w((lambda *s: torch.randn(*s, dtype=torch.bfloat16) * 0.8)(D, H * Dh) * (D ** -0.5)),
            "wo": _w((lambda *s: torch.randn(*s, dtype=torch.bfloat16) * 0.2)(H * Dh, D) * ((H * Dh) ** -0.5)),
        }
    _A_in = _A_setup()

    def _B_setup():
        B, S, D, F = 4, 1, 448, 1792
        return {
            "x": _w((lambda *s: torch.randn(*s, dtype=torch.bfloat16) * 0.05)(B, S, D)),
            "w1": _w((lambda *s: torch.randn(*s, dtype=torch.bfloat16) * 0.1)(D, F)),
            "b1": _w((lambda *s: torch.randn(*s, dtype=torch.bfloat16) * 0.1)(F)),
            "w2": _w((lambda *s: torch.randn(*s, dtype=torch.bfloat16) * 0.1)(F, D)),
            "b2": _w((lambda *s: torch.randn(*s, dtype=torch.bfloat16) * 0.1)(D)),
        }
    _B_in = _B_setup()

    return {
        "A_x": _A_in["x"],
        "A_k_cache": _A_in["k_cache"],
        "A_v_cache": _A_in["v_cache"],
        "A_wq": _A_in["wq"],
        "A_wo": _A_in["wo"],
        "B_x": _B_in["x"],
        "B_w1": _B_in["w1"],
        "B_b1": _B_in["b1"],
        "B_w2": _B_in["w2"],
        "B_b2": _B_in["b2"],
    }

def reference(A_x, A_k_cache, A_v_cache, A_wq, A_wo, B_x, B_w1, B_b1, B_w2, B_b2):
    def _A_ref(x, k_cache, v_cache, wq, wo):
        B, Sq, D = x.shape
        H, Dh = 16, 256
        q = (lambda x, *d: x.permute(*d))((x @ wq).reshape(B, Sq, H, Dh), 0, 2, 1, 3)
        scores = torch.einsum("bhqd,bhkd->bhqk", q, k_cache) * (Dh ** -0.5)
        p = _softmax(scores, axis=-1)
        o = torch.einsum("bhqk,bhkd->bhqd", p, v_cache)
        return (lambda x, *d: x.permute(*d))(o, 0, 2, 1, 3).reshape(B, Sq, H * Dh) @ wo

    def _B_ref(x, w1, b1, w2, b2):
        h = torch.einsum("bsd,df->bsf", x, w1) + b1
        zero = torch.zeros_like(h)
        r = torch.where(h > zero, h, zero)
        h = r * r
        out = torch.einsum("bsf,fd->bsd", h, w2) + b2
        return out

    x = A_x
    xn = _layernorm(x, axis=-1)
    s = _A_ref(xn, A_k_cache, A_v_cache, A_wq, A_wo)
    g = _silu(_B_ref(xn, B_w1, B_b1, B_w2, B_b2))
    return x + s * g
```

```asm
; @launch grid=(256,1,1) block=(512,1,1) lds=28928
.amdgcn_target "amdgcn-amd-amdhsa--gfx950"
.text
.globl recurrent_scan__mha_block_cached__dense_activation_squared_relu__decode_kernel
.p2align 8
.type recurrent_scan__mha_block_cached__dense_activation_squared_relu__decode_kernel,@function
recurrent_scan__mha_block_cached__dense_activation_squared_relu__decode_kernel:
    s_cmp_ge_u32 s2, 256
    s_cbranch_scc1 L_end
    s_load_dwordx16 s[64:79], s[0:1], 0
    s_load_dwordx8 s[80:87], s[0:1], 64
    s_load_dwordx2 s[88:89], s[0:1], 96
    v_lshrrev_b32 v1, 6, v0
    v_and_b32 v0, 63, v0
    v_readfirstlane_b32 s3, v1
    s_and_b32 s52, s2, 15
    s_bfe_u32 s53, s2, 0x20004
    s_lshr_b32 s54, s2, 6
    s_and_b32 s55, s2, 63
    s_lshl_b32 s96, s54, 4
    s_add_u32 s96, s96, s52
    s_lshl_b32 s56, s96, 21
    s_lshl_b32 s57, s53, 19
    s_add_u32 s56, s56, s57
    v_lshlrev_b32 v56, 4, v0
    s_lshl_b32 s57, s3, 12
    v_add_u32 v1, s57, v56
    v_lshrrev_b32 v57, 3, v0
    v_and_b32 v58, 7, v0
    v_lshlrev_b32 v20, 13, v57
    v_lshl_add_u32 v20, v58, 4, v20
    s_mul_i32 s59, s3, 458752
    s_lshl_b32 s6, s52, 9
    s_lshl_b32 s7, s53, 7
    s_add_u32 s6, s6, s7
    s_mul_i32 s57, s54, 896
    s_waitcnt lgkmcnt(0)
    s_add_u32 s8, s66, s56
    s_addc_u32 s9, s67, 0
    s_mov_b32 s10, 524288
    s_mov_b32 s11, 0x20000
    s_mov_b32 s58, 0
    buffer_load_dwordx4 v[64:67], v1, s[8:11], s58 offen offset:0 nt
    buffer_load_dwordx4 v[68:71], v1, s[8:11], s58 offen offset:1024 nt
    buffer_load_dwordx4 v[72:75], v1, s[8:11], s58 offen offset:2048 nt
    buffer_load_dwordx4 v[76:79], v1, s[8:11], s58 offen offset:3072 nt
    s_add_u32 s32, s64, s57
    s_addc_u32 s33, s65, 0
    s_mov_b32 s34, 896
    s_mov_b32 s35, 0x20000
    buffer_load_dwordx4 v[40:43], v56, s[32:35], 0 offen
    s_add_u32 s16, s70, s6
    s_addc_u32 s17, s71, 0
    s_sub_u32 s18, 3670016, s6
    s_mov_b32 s19, 0x20000
    buffer_load_dwordx4 v[128:131], v20, s[16:19], s59 offen
    s_add_u32 s59, s59, 65536
    buffer_load_dwordx4 v[132:135], v20, s[16:19], s59 offen
    s_add_u32 s59, s59, 65536
    buffer_load_dwordx4 v[136:139], v20, s[16:19], s59 offen
    s_add_u32 s59, s59, 65536
    buffer_load_dwordx4 v[140:143], v20, s[16:19], s59 offen
    s_add_u32 s59, s59, 65536
    s_mov_b32 s58, 32768
    buffer_load_dwordx4 v[80:83], v1, s[8:11], s58 offen offset:0 nt
    buffer_load_dwordx4 v[84:87], v1, s[8:11], s58 offen offset:1024 nt
    buffer_load_dwordx4 v[88:91], v1, s[8:11], s58 offen offset:2048 nt
    v_mul_u32_u24 v5, 3584, v57
    v_lshl_add_u32 v5, v58, 3, v5
    v_lshrrev_b32 v59, 5, v0
    v_and_b32 v60, 0x1f0, v56
    v_mul_u32_u24 v3, 14336, v59
    v_add_u32 v3, v3, v60
    v_add_u32 v4, 512, v3
    v_cmp_gt_u32 vcc, 384, v60
    v_mov_b32 v62, 0x80000000
    s_nop 0
    v_cndmask_b32 v4, v62, v4, vcc
    v_and_b32 v62, 1, v0
    v_lshl_add_u32 v62, v59, 4, v62
    s_lshl_b32 s57, s3, 1
    v_add_u32 v55, s57, v62
    v_lshlrev_b32 v51, 1, v55
    s_mul_i32 s61, s3, 200704
    s_mul_i32 s60, s3, 1792
    s_mul_i32 s97, s3, 28672
    s_lshr_b32 s99, s2, 4
    s_lshl_b32 s100, s54, 1
    s_and_b32 s98, s55, 0x30
    s_and_b32 s7, s55, 7
    s_lshl_b32 s7, s7, 1
    s_add_u32 s98, s98, s7
    s_bfe_u32 s7, s55, 0x10003
    s_add_u32 s98, s98, s7
    s_and_b32 s6, s55, 7
    s_add_u32 s6, s6, s7
    s_add_u32 s6, s6, 47
    s_bitcmp1_b32 s55, 0
    s_cselect_b32 s6, s6, 56
    s_cmp_lt_u32 s55, 48
    s_cselect_b32 s98, s98, s6
    s_lshl_b32 s7, s98, 6
    s_add_u32 s24, s76, s7
    s_addc_u32 s25, s77, 0
    s_sub_u32 s26, 1605632, s7
    s_mov_b32 s27, 0x20000
    s_mul_i32 s57, s98, 28672
    s_add_u32 s28, s80, s57
    s_addc_u32 s29, s81, 0
    s_mov_b32 s30, 28672
    s_mov_b32 s31, 0x20000
    s_cmp_lt_u32 s98, 56
    s_cselect_b32 s26, s26, 0
    s_cselect_b32 s30, s30, 0
    s_cmp_lt_u32 s55, 56
    s_cselect_b32 s5, 1, 0
    s_cmp_eq_u32 s3, 7
    s_cselect_b32 s5, s5, 0
    s_mov_b32 s36, s78
    s_mov_b32 s37, s79
    s_mov_b32 s38, 3584
    s_mov_b32 s39, 0x20000
    s_lshl_b32 s57, s54, 8
    s_load_dword s62, s[88:89], s57
    s_add_u32 s12, s68, s56
    s_addc_u32 s13, s69, 0
    s_mov_b32 s14, 524288
    s_mov_b32 s15, 0x20000
    s_mul_i32 s57, s52, 229376
    s_add_u32 s20, s72, s57
    s_addc_u32 s21, s73, 0
    s_mov_b32 s22, 229376
    s_mov_b32 s23, 0x20000
    s_mov_b32 s40, s82
    s_mov_b32 s41, s83
    s_mov_b32 s42, 896
    s_mov_b32 s43, 0x20000
    s_mov_b32 s44, s88
    s_mov_b32 s45, s89
    s_mov_b32 s46, 2097152
    s_mov_b32 s47, 0x20000
    s_mov_b32 s48, s84
    s_mov_b32 s49, s85
    s_mov_b32 s50, 3584
    s_mov_b32 s51, 0x20000
    v_mul_u32_u24 v44, 48, v57
    v_mul_u32_u24 v45, 11, v58
    v_lshrrev_b32 v45, 5, v45
    v_lshl_add_u32 v44, v45, 4, v44
    v_lshrrev_b32 v62, 4, v0
    v_xor_b32 v46, v62, v57
    v_and_b32 v46, 1, v46
    v_lshlrev_b32 v46, 2, v46
    v_lshrrev_b32 v47, 1, v58
    v_add_u32 v46, v46, v47
    v_and_b32 v47, 1, v0
    v_lshlrev_b32 v47, 4, v47
    v_mov_b32 v48, 0xffff
    v_lshlrev_b32 v47, v47, v48
    v_cmp_eq_u32 vcc, 0, v46
    s_nop 1
    v_cndmask_b32 v6, 0, v47, vcc
    v_cmp_eq_u32 vcc, 1, v46
    s_nop 1
    v_cndmask_b32 v7, 0, v47, vcc
    v_cmp_eq_u32 vcc, 2, v46
    s_nop 1
    v_cndmask_b32 v8, 0, v47, vcc
    v_cmp_eq_u32 vcc, 3, v46
    s_nop 1
    v_cndmask_b32 v9, 0, v47, vcc
    v_and_b32 v61, 15, v0
    v_and_b32 v62, 1, v62
    v_lshlrev_b32 v53, 9, v59
    v_lshl_add_u32 v53, v61, 5, v53
    v_lshl_add_u32 v53, v62, 4, v53
    s_mul_i32 s57, s3, 1040
    v_add_u32 v54, s57, v53
    s_lshl_b32 s57, s3, 11
    v_add_u32 v53, s57, v53
    v_lshlrev_b32 v48, 9, v62
    v_lshl_add_u32 v55, v55, 2, v48
    v_mul_u32_u24 v48, 4160, v62
    v_lshl_add_u32 v49, v61, 1, v59
    v_add_u32 v49, s99, v49
    v_and_b32 v49, 15, v49
    v_lshl_add_u32 v49, v62, 4, v49
    s_lshl_b32 s57, s3, 5
    v_add_u32 v49, s57, v49
    v_and_b32 v48, 1, v57
    v_mul_u32_u24 v48, 4160, v48
    v_lshl_add_u32 v49, v49, 2, v48
    v_lshlrev_b32 v10, 4, v62
    v_lshlrev_b32 v11, 2, v0
    s_lshl_b32 s57, s3, 8
    v_add_u32 v11, s57, v11
    v_lshl_add_u32 v63, v62, 1, v59
    v_and_b32 v50, 1, v57
    v_lshl_add_u32 v63, v50, 2, v63
    v_mov_b32 v50, v63
    v_and_b32 v48, 3, v63
    v_lshl_add_u32 v48, v58, 2, v48
    s_lshl_b32 s57, s3, 7
    v_lshl_add_u32 v48, v48, 2, s57
    s_mov_b32 s66, 0xcccccccc
    s_mov_b32 s67, 0xcccccccc
    s_mov_b32 s68, 0xaaaaaaaa
    s_mov_b32 s69, 0xaaaaaaaa
    s_mov_b32 s70, 0x40404040
    s_mov_b32 s71, 0x40404040
    s_mov_b32 s64, 0x49494949
    s_mov_b32 s65, 0x49494949
    s_mov_b32 s72, 0x3db8aa3b
    s_lshl_b32 s96, s96, 10
    s_add_u32 s96, s96, 4096
    s_mul_i32 s63, s54, 172032
    s_mul_i32 s57, s55, 2688
    s_add_u32 s63, s63, s57
    s_mul_i32 s57, s3, 384
    s_add_u32 s63, s63, s57
    s_add_u32 s63, s63, 131072
    s_cmp_eq_u32 s3, 7
    s_cselect_b32 s63, 0x70000000, s63
    s_waitcnt vmcnt(7)
    v_lshlrev_b32 v24, 16, v40
    v_and_b32 v25, 0xffff0000, v40
    v_lshlrev_b32 v26, 16, v41
    v_and_b32 v27, 0xffff0000, v41
    v_lshlrev_b32 v28, 16, v42
    v_and_b32 v29, 0xffff0000, v42
    v_lshlrev_b32 v30, 16, v43
    v_and_b32 v31, 0xffff0000, v43
    v_add_f32 v12, v24, v25
    v_add_f32 v13, v26, v27
    v_add_f32 v14, v28, v29
    v_add_f32 v15, v30, v31
    v_add_f32 v12, v12, v13
    v_add_f32 v14, v14, v15
    v_add_f32 v12, v12, v14
    s_nop 1
    v_add_f32_dpp v12, v12, v12 row_ror:8 row_mask:0xf bank_mask:0xf
    s_nop 1
    v_add_f32_dpp v12, v12, v12 row_ror:4 row_mask:0xf bank_mask:0xf
    s_nop 1
    v_add_f32_dpp v12, v12, v12 row_ror:2 row_mask:0xf bank_mask:0xf
    s_nop 1
    v_add_f32_dpp v12, v12, v12 row_ror:1 row_mask:0xf bank_mask:0xf
    v_mov_b32 v14, v12
    s_nop 1
    v_permlane16_swap_b32 v12, v14
    v_add_f32 v12, v12, v14
    v_mov_b32 v14, v12
    s_nop 1
    v_permlane32_swap_b32 v12, v14
    v_add_f32 v12, v12, v14
    v_mul_f32 v12, 0x3b124925, v12
    v_mov_b32 v13, 0
    v_mov_b32 v15, 0
    s_mov_b32 exec_hi, 0x00ffffff
    v_sub_f32 v32, v24, v12
    v_sub_f32 v33, v25, v12
    v_sub_f32 v34, v26, v12
    v_sub_f32 v35, v27, v12
    v_sub_f32 v36, v28, v12
    v_sub_f32 v37, v29, v12
    v_sub_f32 v38, v30, v12
    v_sub_f32 v39, v31, v12
    v_fmac_f32 v13, v32, v32
    v_fmac_f32 v15, v33, v33
    v_fmac_f32 v13, v34, v34
    v_fmac_f32 v15, v35, v35
    v_fmac_f32 v13, v36, v36
    v_fmac_f32 v15, v37, v37
    v_fmac_f32 v13, v38, v38
    v_fmac_f32 v15, v39, v39
    s_mov_b32 exec_hi, -1
    v_add_f32 v13, v13, v15
    v_cvt_pk_bf16_f32 v12, v12, v12
    v_and_b32 v12, 0xffff0000, v12
    v_add_f32_dpp v13, v13, v13 row_ror:8 row_mask:0xf bank_mask:0xf
    s_nop 1
    v_add_f32_dpp v13, v13, v13 row_ror:4 row_mask:0xf bank_mask:0xf
    s_nop 1
    v_add_f32_dpp v13, v13, v13 row_ror:2 row_mask:0xf bank_mask:0xf
    s_nop 1
    v_add_f32_dpp v13, v13, v13 row_ror:1 row_mask:0xf bank_mask:0xf
    v_sub_f32 v24, v24, v12
    v_sub_f32 v25, v25, v12
    v_sub_f32 v26, v26, v12
    v_sub_f32 v27, v27, v12
    v_sub_f32 v28, v28, v12
    v_sub_f32 v29, v29, v12
    v_sub_f32 v30, v30, v12
    v_sub_f32 v31, v31, v12
    v_mov_b32 v14, v13
    s_nop 1
    v_permlane16_swap_b32 v13, v14
    v_add_f32 v13, v13, v14
    v_cvt_pk_bf16_f32 v40, v24, v25
    v_cvt_pk_bf16_f32 v41, v26, v27
    v_cvt_pk_bf16_f32 v42, v28, v29
    v_cvt_pk_bf16_f32 v43, v30, v31
    v_mov_b32 v14, v13
    s_nop 1
    v_permlane32_swap_b32 v13, v14
    v_add_f32 v13, v13, v14
    v_lshlrev_b32 v24, 16, v40
    v_and_b32 v25, 0xffff0000, v40
    v_lshlrev_b32 v26, 16, v41
    v_and_b32 v27, 0xffff0000, v41
    v_lshlrev_b32 v28, 16, v42
    v_and_b32 v29, 0xffff0000, v42
    v_lshlrev_b32 v30, 16, v43
    v_and_b32 v31, 0xffff0000, v43
    v_mul_f32 v13, 0x3b124925, v13
    v_cvt_pk_bf16_f32 v13, v13, v13
    v_and_b32 v13, 0xffff0000, v13
    v_add_f32 v13, 0x3727c5ac, v13
    v_cvt_pk_bf16_f32 v13, v13, v13
    v_and_b32 v13, 0xffff0000, v13
    v_sqrt_f32 v13, v13
    s_nop 0
    v_cvt_pk_bf16_f32 v13, v13, v13
    v_and_b32 v13, 0xffff0000, v13
    v_rcp_f32 v14, v13
    s_nop 0
    v_mul_f32 v32, v24, v14
    v_mul_f32 v33, v25, v14
    v_mul_f32 v34, v26, v14
    v_mul_f32 v35, v27, v14
    v_mul_f32 v36, v28, v14
    v_mul_f32 v37, v29, v14
    v_mul_f32 v38, v30, v14
    v_mul_f32 v39, v31, v14
    v_fma_f32 v24, -v32, v13, v24
    v_fma_f32 v25, -v33, v13, v25
    v_fma_f32 v26, -v34, v13, v26
    v_fma_f32 v27, -v35, v13, v27
    v_fma_f32 v28, -v36, v13, v28
    v_fma_f32 v29, -v37, v13, v29
    v_fma_f32 v30, -v38, v13, v30
    v_fma_f32 v31, -v39, v13, v31
    v_fmac_f32 v32, v24, v14
    v_fmac_f32 v33, v25, v14
    v_fmac_f32 v34, v26, v14
    v_fmac_f32 v35, v27, v14
    v_fmac_f32 v36, v28, v14
    v_fmac_f32 v37, v29, v14
    v_fmac_f32 v38, v30, v14
    v_fmac_f32 v39, v31, v14
    v_cvt_pk_bf16_f32 v40, v32, v33
    v_cvt_pk_bf16_f32 v41, v34, v35
    v_cvt_pk_bf16_f32 v42, v36, v37
    v_cvt_pk_bf16_f32 v43, v38, v39
    ds_write_b128 v56, v[40:43] offset:10432
    s_mul_i32 s57, s3, 112
    v_lshl_add_u32 v45, v57, 1, s57
    s_waitcnt lgkmcnt(0)
    ds_read_u16 v24, v45 offset:10432
    ds_read_u16 v25, v45 offset:10448
    ds_read_u16 v26, v45 offset:10464
    ds_read_u16 v27, v45 offset:10480
    ds_read_u16 v28, v45 offset:10496
    ds_read_u16 v29, v45 offset:10512
    ds_read_u16 v30, v45 offset:10528
    s_mul_i32 s62, s62, 0x9E3779B1
    s_add_u32 s62, s62, 0x7F4A7C15
    v_mov_b32 v32, 0
    v_mov_b32 v33, 0
    v_mov_b32 v34, 0
    v_mov_b32 v35, 0
    v_mov_b32 v36, 0
    v_mov_b32 v37, 0
    v_mov_b32 v38, 0
    v_mov_b32 v39, 0
    v_lshl_add_u32 v52, v58, 3, v63
    s_lshl_b32 s57, s3, 8
    v_lshl_add_u32 v52, v52, 2, s57
    s_waitcnt lgkmcnt(0)
    buffer_load_dwordx4 v[144:147], v20, s[16:19], s59 offen
    s_add_u32 s59, s59, 65536
    buffer_load_dwordx4 v[148:151], v20, s[16:19], s59 offen
    s_add_u32 s59, s59, 65536
    buffer_load_dwordx4 v[152:155], v20, s[16:19], s59 offen
    buffer_load_dwordx4 v[92:95], v1, s[8:11], s58 offen offset:3072 nt
    s_waitcnt vmcnt(6)
    s_mov_b32 s58, 65536
    buffer_load_dwordx4 v[96:99], v1, s[8:11], s58 offen offset:0 nt
    buffer_load_dwordx4 v[100:103], v1, s[8:11], s58 offen offset:1024 nt
    buffer_load_dwordx4 v[104:107], v1, s[8:11], s58 offen offset:2048 nt
    buffer_load_dwordx4 v[108:111], v1, s[8:11], s58 offen offset:3072 nt
    v_lshlrev_b32 v40, 16, v24
    v_dot2c_f32_bf16 v32, v128, v24
    v_dot2c_f32_bf16 v34, v129, v24
    v_dot2c_f32_bf16 v36, v130, v24
    v_dot2c_f32_bf16 v38, v131, v24
    v_dot2c_f32_bf16 v33, v128, v40
    v_dot2c_f32_bf16 v35, v129, v40
    v_dot2c_f32_bf16 v37, v130, v40
    v_dot2c_f32_bf16 v39, v131, v40
    v_lshlrev_b32 v41, 16, v25
    v_dot2c_f32_bf16 v32, v132, v25
    v_dot2c_f32_bf16 v34, v133, v25
    v_dot2c_f32_bf16 v36, v134, v25
    v_dot2c_f32_bf16 v38, v135, v25
    v_dot2c_f32_bf16 v33, v132, v41
    v_dot2c_f32_bf16 v35, v133, v41
    v_dot2c_f32_bf16 v37, v134, v41
    v_dot2c_f32_bf16 v39, v135, v41
    v_lshlrev_b32 v40, 16, v26
    v_dot2c_f32_bf16 v32, v136, v26
    v_dot2c_f32_bf16 v34, v137, v26
    v_dot2c_f32_bf16 v36, v138, v26
    v_dot2c_f32_bf16 v38, v139, v26
    v_dot2c_f32_bf16 v33, v136, v40
    v_dot2c_f32_bf16 v35, v137, v40
    v_dot2c_f32_bf16 v37, v138, v40
    v_dot2c_f32_bf16 v39, v139, v40
    v_lshlrev_b32 v41, 16, v27
    v_dot2c_f32_bf16 v32, v140, v27
    v_dot2c_f32_bf16 v34, v141, v27
    v_dot2c_f32_bf16 v36, v142, v27
    v_dot2c_f32_bf16 v38, v143, v27
    v_dot2c_f32_bf16 v33, v140, v41
    v_dot2c_f32_bf16 v35, v141, v41
    v_dot2c_f32_bf16 v37, v142, v41
    v_dot2c_f32_bf16 v39, v143, v41
    v_lshlrev_b32 v40, 16, v28
    s_waitcnt vmcnt(7)
    v_dot2c_f32_bf16 v32, v144, v28
    v_dot2c_f32_bf16 v34, v145, v28
    v_dot2c_f32_bf16 v36, v146, v28
    v_dot2c_f32_bf16 v38, v147, v28
    v_dot2c_f32_bf16 v33, v144, v40
    v_dot2c_f32_bf16 v35, v145, v40
    v_dot2c_f32_bf16 v37, v146, v40
    v_dot2c_f32_bf16 v39, v147, v40
    v_lshlrev_b32 v41, 16, v29
    s_waitcnt vmcnt(6)
    v_dot2c_f32_bf16 v32, v148, v29
    v_dot2c_f32_bf16 v34, v149, v29
    v_dot2c_f32_bf16 v36, v150, v29
    v_dot2c_f32_bf16 v38, v151, v29
    v_dot2c_f32_bf16 v33, v148, v41
    v_dot2c_f32_bf16 v35, v149, v41
    v_dot2c_f32_bf16 v37, v150, v41
    v_dot2c_f32_bf16 v39, v151, v41
    v_lshlrev_b32 v40, 16, v30
    s_waitcnt vmcnt(5)
    v_dot2c_f32_bf16 v32, v152, v30
    v_dot2c_f32_bf16 v34, v153, v30
    v_dot2c_f32_bf16 v36, v154, v30
    v_dot2c_f32_bf16 v38, v155, v30
    v_dot2c_f32_bf16 v33, v152, v40
    v_dot2c_f32_bf16 v35, v153, v40
    v_dot2c_f32_bf16 v37, v154, v40
    v_dot2c_f32_bf16 v39, v155, v40
    v_permlane32_swap_b32 v32, v33
    v_permlane32_swap_b32 v34, v35
    v_permlane32_swap_b32 v36, v37
    v_permlane32_swap_b32 v38, v39
    v_add_f32 v32, v32, v33
    v_add_f32 v34, v34, v35
    v_add_f32 v36, v36, v37
    v_add_f32 v38, v38, v39
    v_permlane16_swap_b32 v32, v34
    s_nop 0
    v_permlane16_swap_b32 v36, v38
    v_add_f32 v32, v32, v34
    v_add_f32 v36, v36, v38
    s_nop 0
    v_add_f32_dpp v32, v32, v32 row_ror:8 row_mask:0xf bank_mask:0x3
    s_nop 1
    v_add_f32_dpp v32, v36, v36 row_ror:8 row_mask:0xf bank_mask:0xc
    ds_write_b32 v52, v32 offset:8320
    v_mov_b32 v34, 0
    v_mov_b32 v35, 0
    ds_write_b64 v34, v[34:35] offset:11456
    ds_write_b32 v34, v35 offset:11464
    s_mov_b32 s58, 98304
    buffer_load_dwordx4 v[112:115], v1, s[8:11], s58 offen offset:0 nt
    buffer_load_dwordx4 v[116:119], v1, s[8:11], s58 offen offset:1024 nt
    s_mul_i32 s7, s100, 28672
    s_add_u32 s7, s7, s61
    buffer_load_dwordx2 v[224:225], v5, s[24:27], s7 offen
    s_add_u32 s100, s100, 1
    s_cmp_eq_u32 s100, 7
    s_cselect_b32 s100, 0, s100
    s_waitcnt lgkmcnt(0)
    s_barrier
    s_cmp_lg_u32 s3, 0
    s_cbranch_scc1 L_nopub
    ds_read_b32 v12, v11 offset:8320
    ds_read_b32 v13, v11 offset:8576
    ds_read_b32 v14, v11 offset:8832
    ds_read_b32 v15, v11 offset:9088
    ds_read_b32 v16, v11 offset:9344
    ds_read_b32 v17, v11 offset:9600
    ds_read_b32 v18, v11 offset:9856
    ds_read_b32 v19, v11 offset:10112
    v_mov_b32 v41, s62
    v_mov_b32 v43, s62
    s_lshl_b32 s57, s53, 8
    s_add_u32 s57, s57, s96
    s_waitcnt lgkmcnt(0)
    v_add_f32 v12, v12, v16
    v_add_f32 v13, v13, v17
    v_add_f32 v14, v14, v18
    v_add_f32 v15, v15, v19
    v_add_f32 v12, v12, v13
    v_add_f32 v14, v14, v15
    v_add_f32 v12, v12, v14
    s_nop 1
    v_mov_b32_dpp v13, v12 row_shl:1 row_mask:0xf bank_mask:0xf
    v_cvt_pk_bf16_f32 v40, v12, v13
    s_nop 1
    v_mov_b32_dpp v42, v40 row_shl:2 row_mask:0xf bank_mask:0xf
    s_mov_b32 exec_lo, 0x11111111
    s_mov_b32 exec_hi, 0x11111111
    buffer_store_dwordx4 v[40:43], v11, s[44:47], s57 offen sc1
    s_mov_b64 exec, -1
    s_nop 1
L_nopub:
    v_lshlrev_b32 v52, 1, v60
    s_waitcnt vmcnt(4)
    buffer_load_dwordx4 v[120:123], v1, s[8:11], s58 offen offset:2048 nt
    s_waitcnt vmcnt(4)
    buffer_load_dwordx4 v[124:127], v1, s[8:11], s58 offen offset:3072 nt
    s_mul_i32 s7, s100, 28672
    s_add_u32 s7, s7, s61
    buffer_load_dwordx2 v[226:227], v5, s[24:27], s7 offen
    s_add_u32 s100, s100, 1
    s_cmp_eq_u32 s100, 7
    s_cselect_b32 s100, 0, s100
    s_waitcnt vmcnt(5)
    s_mov_b32 s58, 131072
    buffer_load_dwordx4 v[176:179], v1, s[8:11], s58 offen offset:0 nt
    s_waitcnt vmcnt(5)
    buffer_load_dwordx4 v[180:183], v1, s[8:11], s58 offen offset:1024 nt
    s_mul_i32 s7, s100, 28672
    s_add_u32 s7, s7, s61
    buffer_load_dwordx2 v[228:229], v5, s[24:27], s7 offen
    s_add_u32 s100, s100, 1
    s_cmp_eq_u32 s100, 7
    s_cselect_b32 s100, 0, s100
    s_waitcnt vmcnt(5)
    buffer_load_dwordx4 v[184:187], v1, s[8:11], s58 offen offset:2048 nt
    s_waitcnt vmcnt(5)
    buffer_load_dwordx4 v[188:191], v1, s[8:11], s58 offen offset:3072 nt
    s_mul_i32 s7, s100, 28672
    s_add_u32 s7, s7, s61
    buffer_load_dwordx2 v[230:231], v5, s[24:27], s7 offen
    s_add_u32 s100, s100, 1
    s_cmp_eq_u32 s100, 7
    s_cselect_b32 s100, 0, s100
    s_waitcnt vmcnt(5)
    s_mov_b32 s58, 163840
    buffer_load_dwordx4 v[192:195], v1, s[8:11], s58 offen offset:0 nt
    s_waitcnt vmcnt(5)
    buffer_load_dwordx4 v[196:199], v1, s[8:11], s58 offen offset:1024 nt
    s_mul_i32 s7, s100, 28672
    s_add_u32 s7, s7, s61
    buffer_load_dwordx2 v[232:233], v5, s[24:27], s7 offen
    s_add_u32 s100, s100, 1
    s_cmp_eq_u32 s100, 7
    s_cselect_b32 s100, 0, s100
    s_waitcnt vmcnt(5)
    buffer_load_dwordx4 v[200:203], v1, s[8:11], s58 offen offset:2048 nt
    s_waitcnt vmcnt(5)
    buffer_load_dwordx4 v[204:207], v1, s[8:11], s58 offen offset:3072 nt
    s_mul_i32 s7, s100, 28672
    s_add_u32 s7, s7, s61
    buffer_load_dwordx2 v[234:235], v5, s[24:27], s7 offen
    s_add_u32 s100, s100, 1
    s_cmp_eq_u32 s100, 7
    s_cselect_b32 s100, 0, s100
    s_waitcnt vmcnt(5)
    s_mov_b32 s58, 196608
    buffer_load_dwordx4 v[208:211], v1, s[8:11], s58 offen offset:0 nt
    s_waitcnt vmcnt(5)
    buffer_load_dwordx4 v[212:215], v1, s[8:11], s58 offen offset:1024 nt
    s_mul_i32 s7, s100, 28672
    s_add_u32 s7, s7, s61
    buffer_load_dwordx2 v[236:237], v5, s[24:27], s7 offen
    s_add_u32 s100, s100, 1
    s_cmp_eq_u32 s100, 7
    s_cselect_b32 s100, 0, s100
    buffer_load_dwordx4 v[12:15], v52, s[44:47], s96 offen sc1
    buffer_load_dwordx4 v[16:19], v52, s[44:47], s96 offen offset:16 sc1
    s_waitcnt vmcnt(7)
    buffer_load_dwordx4 v[216:219], v1, s[8:11], s58 offen offset:2048 nt
    s_waitcnt vmcnt(7)
    buffer_load_dwordx4 v[220:223], v1, s[8:11], s58 offen offset:3072 nt
    buffer_load_dwordx4 v[240:243], v3, s[28:31], s60 offen offset:0
    s_waitcnt vmcnt(3)
    s_mov_b32 s74, 0
L_qchk:
    v_cmp_eq_u32 s[76:77], s62, v13
    v_cmp_eq_u32 s[78:79], s62, v15
    v_cmp_eq_u32 s[80:81], s62, v17
    v_cmp_eq_u32 vcc, s62, v19
    s_and_b64 s[76:77], s[76:77], s[78:79]
    s_and_b64 vcc, vcc, s[80:81]
    s_and_b64 vcc, vcc, s[76:77]
    s_cmp_eq_u64 vcc, -1
    s_cbranch_scc1 L_qok
    s_add_u32 s74, s74, 1
    s_cmp_gt_u32 s74, 0x400000
    s_cbranch_scc1 L_qok
    s_sleep 2
    buffer_load_dwordx4 v[12:15], v52, s[44:47], s96 offen sc1
    buffer_load_dwordx4 v[16:19], v52, s[44:47], s96 offen offset:16 sc1
    s_waitcnt vmcnt(0)
    s_branch L_qchk
L_qok:
    s_getreg_b32 s76, hwreg(HW_REG_XCC_ID)
    s_bitcmp1_b32 s76, 0
    s_cselect_b64 vcc, -1, 0
    v_mov_b32 v56, 0
    v_dot2c_f32_bf16 v56, v64, v12
    v_dot2c_f32_bf16 v56, v65, v14
    v_dot2c_f32_bf16 v56, v66, v16
    v_dot2c_f32_bf16 v56, v67, v18
    v_mov_b32 v57, 0
    v_dot2c_f32_bf16 v57, v68, v12
    v_dot2c_f32_bf16 v57, v69, v14
    v_dot2c_f32_bf16 v57, v70, v16
    v_dot2c_f32_bf16 v57, v71, v18
    v_add_f32_dpp v56, v56, v56 row_ror:8 row_mask:0xf bank_mask:0x3
    s_nop 1
    v_add_f32_dpp v56, v57, v57 row_ror:8 row_mask:0xf bank_mask:0xc
    v_mov_b32 v58, 0
    v_dot2c_f32_bf16 v58, v72, v12
    v_dot2c_f32_bf16 v58, v73, v14
    v_dot2c_f32_bf16 v58, v74, v16
    v_dot2c_f32_bf16 v58, v75, v18
    v_mov_b32 v59, 0
    v_dot2c_f32_bf16 v59, v76, v12
    v_dot2c_f32_bf16 v59, v77, v14
    v_dot2c_f32_bf16 v59, v78, v16
    v_dot2c_f32_bf16 v59, v79, v18
    v_add_f32_dpp v58, v58, v58 row_ror:8 row_mask:0xf bank_mask:0x3
    s_nop 1
    v_add_f32_dpp v58, v59, v59 row_ror:8 row_mask:0xf bank_mask:0xc
    v_add_f32_dpp v60, v56, v56 row_half_mirror row_mask:0xf bank_mask:0x5
    s_nop 1
    v_add_f32_dpp v60, v58, v58 row_half_mirror row_mask:0xf bank_mask:0xa
    v_mov_b32 v56, 0
    v_dot2c_f32_bf16 v56, v80, v12
    v_dot2c_f32_bf16 v56, v81, v14
    v_dot2c_f32_bf16 v56, v82, v16
    v_dot2c_f32_bf16 v56, v83, v18
    v_mov_b32 v57, 0
    v_dot2c_f32_bf16 v57, v84, v12
    v_dot2c_f32_bf16 v57, v85, v14
    v_dot2c_f32_bf16 v57, v86, v16
    v_dot2c_f32_bf16 v57, v87, v18
    v_add_f32_dpp v56, v56, v56 row_ror:8 row_mask:0xf bank_mask:0x3
    s_nop 1
    v_add_f32_dpp v56, v57, v57 row_ror:8 row_mask:0xf bank_mask:0xc
    v_mov_b32 v58, 0
    v_dot2c_f32_bf16 v58, v88, v12
    v_dot2c_f32_bf16 v58, v89, v14
    v_dot2c_f32_bf16 v58, v90, v16
    v_dot2c_f32_bf16 v58, v91, v18
    v_mov_b32 v59, 0
    v_dot2c_f32_bf16 v59, v92, v12
    v_dot2c_f32_bf16 v59, v93, v14
    v_dot2c_f32_bf16 v59, v94, v16
    v_dot2c_f32_bf16 v59, v95, v18
    v_add_f32_dpp v58, v58, v58 row_ror:8 row_mask:0xf bank_mask:0x3
    s_nop 1
    v_add_f32_dpp v58, v59, v59 row_ror:8 row_mask:0xf bank_mask:0xc
    v_add_f32_dpp v61, v56, v56 row_half_mirror row_mask:0xf bank_mask:0x5
    s_nop 1
    v_add_f32_dpp v61, v58, v58 row_half_mirror row_mask:0xf bank_mask:0xa
    v_add_f32_dpp v60, v60, v60 quad_perm:[2,3,0,1] row_mask:0xf bank_mask:0xf
    s_nop 0
    v_add_f32_dpp v61, v61, v61 quad_perm:[2,3,0,1] row_mask:0xf bank_mask:0xf
    v_cndmask_b32 v62, v60, v61, s[66:67]
    v_mov_b32 v56, 0
    v_dot2c_f32_bf16 v56, v96, v12
    v_dot2c_f32_bf16 v56, v97, v14
    v_dot2c_f32_bf16 v56, v98, v16
    v_dot2c_f32_bf16 v56, v99, v18
    v_mov_b32 v57, 0
    v_dot2c_f32_bf16 v57, v100, v12
    v_dot2c_f32_bf16 v57, v101, v14
    v_dot2c_f32_bf16 v57, v102, v16
    v_dot2c_f32_bf16 v57, v103, v18
    v_add_f32_dpp v56, v56, v56 row_ror:8 row_mask:0xf bank_mask:0x3
    s_nop 1
    v_add_f32_dpp v56, v57, v57 row_ror:8 row_mask:0xf bank_mask:0xc
    v_mov_b32 v58, 0
    v_dot2c_f32_bf16 v58, v104, v12
    v_dot2c_f32_bf16 v58, v105, v14
    v_dot2c_f32_bf16 v58, v106, v16
    v_dot2c_f32_bf16 v58, v107, v18
    v_mov_b32 v59, 0
    v_dot2c_f32_bf16 v59, v108, v12
    v_dot2c_f32_bf16 v59, v109, v14
    v_dot2c_f32_bf16 v59, v110, v16
    v_dot2c_f32_bf16 v59, v111, v18
    v_add_f32_dpp v58, v58, v58 row_ror:8 row_mask:0xf bank_mask:0x3
    s_nop 1
    v_add_f32_dpp v58, v59, v59 row_ror:8 row_mask:0xf bank_mask:0xc
    v_add_f32_dpp v60, v56, v56 row_half_mirror row_mask:0xf bank_mask:0x5
    s_nop 1
    v_add_f32_dpp v60, v58, v58 row_half_mirror row_mask:0xf bank_mask:0xa
    v_mov_b32 v56, 0
    v_dot2c_f32_bf16 v56, v112, v12
    v_dot2c_f32_bf16 v56, v113, v14
    v_dot2c_f32_bf16 v56, v114, v16
    v_dot2c_f32_bf16 v56, v115, v18
    v_mov_b32 v57, 0
    v_dot2c_f32_bf16 v57, v116, v12
    v_dot2c_f32_bf16 v57, v117, v14
    v_dot2c_f32_bf16 v57, v118, v16
    v_dot2c_f32_bf16 v57, v119, v18
    v_add_f32_dpp v56, v56, v56 row_ror:8 row_mask:0xf bank_mask:0x3
    s_nop 1
    v_add_f32_dpp v56, v57, v57 row_ror:8 row_mask:0xf bank_mask:0xc
    v_mov_b32 v58, 0
    v_dot2c_f32_bf16 v58, v120, v12
    v_dot2c_f32_bf16 v58, v121, v14
    v_dot2c_f32_bf16 v58, v122, v16
    v_dot2c_f32_bf16 v58, v123, v18
    v_mov_b32 v59, 0
    v_dot2c_f32_bf16 v59, v124, v12
    v_dot2c_f32_bf16 v59, v125, v14
    v_dot2c_f32_bf16 v59, v126, v16
    v_dot2c_f32_bf16 v59, v127, v18
    v_add_f32_dpp v58, v58, v58 row_ror:8 row_mask:0xf bank_mask:0x3
    s_nop 1
    v_add_f32_dpp v58, v59, v59 row_ror:8 row_mask:0xf bank_mask:0xc
    v_add_f32_dpp v61, v56, v56 row_half_mirror row_mask:0xf bank_mask:0x5
    s_nop 1
    v_add_f32_dpp v61, v58, v58 row_half_mirror row_mask:0xf bank_mask:0xa
    v_add_f32_dpp v60, v60, v60 quad_perm:[2,3,0,1] row_mask:0xf bank_mask:0xf
    s_nop 0
    v_add_f32_dpp v61, v61, v61 quad_perm:[2,3,0,1] row_mask:0xf bank_mask:0xf
    v_cndmask_b32 v63, v60, v61, s[66:67]
    v_add_f32_dpp v62, v62, v62 quad_perm:[1,0,3,2] row_mask:0xf bank_mask:0xf
    s_nop 0
    v_add_f32_dpp v63, v63, v63 quad_perm:[1,0,3,2] row_mask:0xf bank_mask:0xf
    v_cndmask_b32 v20, v62, v63, s[68:69]
    v_mov_b32 v62, v20
    s_nop 1
    v_permlane16_swap_b32 v20, v62
    v_add_f32 v20, v20, v62
    v_cvt_pk_bf16_f32 v20, v20, v20
    v_and_b32 v20, 0xffff0000, v20
    v_mov_b32 v56, 0
    v_dot2c_f32_bf16 v56, v176, v12
    v_dot2c_f32_bf16 v56, v177, v14
    v_dot2c_f32_bf16 v56, v178, v16
    v_dot2c_f32_bf16 v56, v179, v18
    v_mov_b32 v57, 0
    v_dot2c_f32_bf16 v57, v180, v12
    v_dot2c_f32_bf16 v57, v181, v14
    v_dot2c_f32_bf16 v57, v182, v16
    v_dot2c_f32_bf16 v57, v183, v18
    v_add_f32_dpp v56, v56, v56 row_ror:8 row_mask:0xf bank_mask:0x3
    s_nop 1
    v_add_f32_dpp v56, v57, v57 row_ror:8 row_mask:0xf bank_mask:0xc
    v_mov_b32 v58, 0
    v_dot2c_f32_bf16 v58, v184, v12
    v_dot2c_f32_bf16 v58, v185, v14
    v_dot2c_f32_bf16 v58, v186, v16
    v_dot2c_f32_bf16 v58, v187, v18
    v_mov_b32 v59, 0
    v_dot2c_f32_bf16 v59, v188, v12
    v_dot2c_f32_bf16 v59, v189, v14
    v_dot2c_f32_bf16 v59, v190, v16
    v_dot2c_f32_bf16 v59, v191, v18
    v_add_f32_dpp v58, v58, v58 row_ror:8 row_mask:0xf bank_mask:0x3
    s_nop 1
    v_add_f32_dpp v58, v59, v59 row_ror:8 row_mask:0xf bank_mask:0xc
    v_add_f32_dpp v60, v56, v56 row_half_mirror row_mask:0xf bank_mask:0x5
    s_nop 1
    v_add_f32_dpp v60, v58, v58 row_half_mirror row_mask:0xf bank_mask:0xa
    v_mov_b32 v56, 0
    v_dot2c_f32_bf16 v56, v192, v12
    v_dot2c_f32_bf16 v56, v193, v14
    v_dot2c_f32_bf16 v56, v194, v16
    v_dot2c_f32_bf16 v56, v195, v18
    v_mov_b32 v57, 0
    v_dot2c_f32_bf16 v57, v196, v12
    v_dot2c_f32_bf16 v57, v197, v14
    v_dot2c_f32_bf16 v57, v198, v16
    v_dot2c_f32_bf16 v57, v199, v18
    v_add_f32_dpp v56, v56, v56 row_ror:8 row_mask:0xf bank_mask:0x3
    s_nop 1
    v_add_f32_dpp v56, v57, v57 row_ror:8 row_mask:0xf bank_mask:0xc
    v_mov_b32 v58, 0
    v_dot2c_f32_bf16 v58, v200, v12
    v_dot2c_f32_bf16 v58, v201, v14
    v_dot2c_f32_bf16 v58, v202, v16
    v_dot2c_f32_bf16 v58, v203, v18
    v_mov_b32 v59, 0
    v_dot2c_f32_bf16 v59, v204, v12
    v_dot2c_f32_bf16 v59, v205, v14
    v_dot2c_f32_bf16 v59, v206, v16
    v_dot2c_f32_bf16 v59, v207, v18
    v_add_f32_dpp v58, v58, v58 row_ror:8 row_mask:0xf bank_mask:0x3
    s_nop 1
    v_add_f32_dpp v58, v59, v59 row_ror:8 row_mask:0xf bank_mask:0xc
    v_add_f32_dpp v61, v56, v56 row_half_mirror row_mask:0xf bank_mask:0x5
    s_nop 1
    v_add_f32_dpp v61, v58, v58 row_half_mirror row_mask:0xf bank_mask:0xa
    v_add_f32_dpp v60, v60, v60 quad_perm:[2,3,0,1] row_mask:0xf bank_mask:0xf
    s_nop 0
    v_add_f32_dpp v61, v61, v61 quad_perm:[2,3,0,1] row_mask:0xf bank_mask:0xf
    v_cndmask_b32 v62, v60, v61, s[66:67]
    v_mov_b32 v56, 0
    v_dot2c_f32_bf16 v56, v208, v12
    v_dot2c_f32_bf16 v56, v209, v14
    v_dot2c_f32_bf16 v56, v210, v16
    v_dot2c_f32_bf16 v56, v211, v18
    s_mov_b32 s58, 229376
    buffer_load_dwordx4 v[64:67], v1, s[8:11], s58 offen offset:0 nt
    v_mov_b32 v57, 0
    v_dot2c_f32_bf16 v57, v212, v12
    v_dot2c_f32_bf16 v57, v213, v14
    v_dot2c_f32_bf16 v57, v214, v16
    v_dot2c_f32_bf16 v57, v215, v18
    buffer_load_dwordx4 v[68:71], v1, s[8:11], s58 offen offset:1024 nt
    buffer_load_dwordx4 v[244:247], v4, s[28:31], s60 offen offset:0
    v_add_f32_dpp v56, v56, v56 row_ror:8 row_mask:0xf bank_mask:0x3
    s_nop 1
    v_add_f32_dpp v56, v57, v57 row_ror:8 row_mask:0xf bank_mask:0xc
    v_mov_b32 v58, 0
    s_waitcnt vmcnt(5)
    v_dot2c_f32_bf16 v58, v216, v12
    v_dot2c_f32_bf16 v58, v217, v14
    v_dot2c_f32_bf16 v58, v218, v16
    v_dot2c_f32_bf16 v58, v219, v18
    s_cbranch_vccnz L_xt1
    s_waitcnt vmcnt(4)
L_xt1:
    buffer_load_dwordx4 v[72:75], v1, s[8:11], s58 offen offset:2048 nt
    v_mov_b32 v59, 0
    s_waitcnt vmcnt(5)
    v_dot2c_f32_bf16 v59, v220, v12
    v_dot2c_f32_bf16 v59, v221, v14
    v_dot2c_f32_bf16 v59, v222, v16
    v_dot2c_f32_bf16 v59, v223, v18
    s_cbranch_vccnz L_xt2
    s_waitcnt vmcnt(3)
L_xt2:
    buffer_load_dwordx4 v[76:79], v1, s[8:11], s58 offen offset:3072 nt
    buffer_load_dwordx4 v[248:251], v3, s[28:31], s60 offen offset:896
    v_add_f32_dpp v58, v58, v58 row_ror:8 row_mask:0xf bank_mask:0x3
    s_nop 1
    v_add_f32_dpp v58, v59, v59 row_ror:8 row_mask:0xf bank_mask:0xc
    v_add_f32_dpp v60, v56, v56 row_half_mirror row_mask:0xf bank_mask:0x5
    s_nop 1
    v_add_f32_dpp v60, v58, v58 row_half_mirror row_mask:0xf bank_mask:0xa
    v_mov_b32 v56, 0
    s_waitcnt vmcnt(5)
    v_dot2c_f32_bf16 v56, v64, v12
    v_dot2c_f32_bf16 v56, v65, v14
    v_dot2c_f32_bf16 v56, v66, v16
    v_dot2c_f32_bf16 v56, v67, v18
    s_mov_b32 s58, 262144
    buffer_load_dwordx4 v[80:83], v1, s[8:11], s58 offen offset:0 nt
    v_mov_b32 v57, 0
    s_waitcnt vmcnt(5)
    v_dot2c_f32_bf16 v57, v68, v12
    v_dot2c_f32_bf16 v57, v69, v14
    v_dot2c_f32_bf16 v57, v70, v16
    v_dot2c_f32_bf16 v57, v71, v18
    s_cbranch_vccnz L_xt3
    s_waitcnt vmcnt(3)
L_xt3:
    buffer_load_dwordx4 v[84:87], v1, s[8:11], s58 offen offset:1024 nt
    buffer_load_dwordx4 v[252:255], v4, s[28:31], s60 offen offset:896
    v_add_f32_dpp v56, v56, v56 row_ror:8 row_mask:0xf bank_mask:0x3
    s_nop 1
    v_add_f32_dpp v56, v57, v57 row_ror:8 row_mask:0xf bank_mask:0xc
    v_mov_b32 v58, 0
    s_waitcnt vmcnt(5)
    v_dot2c_f32_bf16 v58, v72, v12
    v_dot2c_f32_bf16 v58, v73, v14
    v_dot2c_f32_bf16 v58, v74, v16
    v_dot2c_f32_bf16 v58, v75, v18
    s_cbranch_vccnz L_xt4
    s_waitcnt vmcnt(4)
L_xt4:
    buffer_load_dwordx4 v[88:91], v1, s[8:11], s58 offen offset:2048 nt
    v_mov_b32 v59, 0
    s_waitcnt vmcnt(5)
    v_dot2c_f32_bf16 v59, v76, v12
    v_dot2c_f32_bf16 v59, v77, v14
    v_dot2c_f32_bf16 v59, v78, v16
    v_dot2c_f32_bf16 v59, v79, v18
    buffer_load_dwordx4 v[92:95], v1, s[8:11], s58 offen offset:3072 nt
    s_lshl_b32 s7, s98, 6
    buffer_load_ushort v51, v51, s[36:39], s7 offen
    v_add_f32_dpp v58, v58, v58 row_ror:8 row_mask:0xf bank_mask:0x3
    s_nop 1
    v_add_f32_dpp v58, v59, v59 row_ror:8 row_mask:0xf bank_mask:0xc
    v_add_f32_dpp v61, v56, v56 row_half_mirror row_mask:0xf bank_mask:0x5
    s_nop 1
    v_add_f32_dpp v61, v58, v58 row_half_mirror row_mask:0xf bank_mask:0xa
    v_add_f32_dpp v60, v60, v60 quad_perm:[2,3,0,1] row_mask:0xf bank_mask:0xf
    s_nop 0
    v_add_f32_dpp v61, v61, v61 quad_perm:[2,3,0,1] row_mask:0xf bank_mask:0xf
    v_cndmask_b32 v63, v60, v61, s[66:67]
    v_add_f32_dpp v62, v62, v62 quad_perm:[1,0,3,2] row_mask:0xf bank_mask:0xf
    s_nop 0
    v_add_f32_dpp v63, v63, v63 quad_perm:[1,0,3,2] row_mask:0xf bank_mask:0xf
    v_cndmask_b32 v21, v62, v63, s[68:69]
    v_mov_b32 v62, v21
    s_nop 1
    v_permlane16_swap_b32 v21, v62
    v_add_f32 v21, v21, v62
    v_cvt_pk_bf16_f32 v21, v21, v21
    v_and_b32 v21, 0xffff0000, v21
    v_mov_b32 v56, 0
    s_waitcnt vmcnt(5)
    v_dot2c_f32_bf16 v56, v80, v12
    v_dot2c_f32_bf16 v56, v81, v14
    v_dot2c_f32_bf16 v56, v82, v16
    v_dot2c_f32_bf16 v56, v83, v18
    s_cbranch_vccnz L_xt5
    s_waitcnt vmcnt(4)
L_xt5:
    s_mov_b32 s58, 294912
    buffer_load_dwordx4 v[96:99], v1, s[8:11], s58 offen offset:0 nt
    v_mov_b32 v57, 0
    s_waitcnt vmcnt(5)
    v_dot2c_f32_bf16 v57, v84, v12
    v_dot2c_f32_bf16 v57, v85, v14
    v_dot2c_f32_bf16 v57, v86, v16
    v_dot2c_f32_bf16 v57, v87, v18
    s_cbranch_vccnz L_xt6
    s_waitcnt vmcnt(3)
L_xt6:
    buffer_load_dwordx4 v[100:103], v1, s[8:11], s58 offen offset:1024 nt
    s_add_u32 s75, s99, 0
    s_and_b32 s75, s75, 15
    s_mul_i32 s75, s75, 896
    s_add_u32 s75, s75, s97
    buffer_load_dwordx4 v[128:131], v3, s[20:23], s75 offen
    v_add_f32_dpp v56, v56, v56 row_ror:8 row_mask:0xf bank_mask:0x3
    s_nop 1
    v_add_f32_dpp v56, v57, v57 row_ror:8 row_mask:0xf bank_mask:0xc
    v_mov_b32 v58, 0
    s_waitcnt vmcnt(5)
    v_dot2c_f32_bf16 v58, v88, v12
    v_dot2c_f32_bf16 v58, v89, v14
    v_dot2c_f32_bf16 v58, v90, v16
    v_dot2c_f32_bf16 v58, v91, v18
    buffer_load_dwordx4 v[104:107], v1, s[8:11], s58 offen offset:2048 nt
    v_mov_b32 v59, 0
    s_waitcnt vmcnt(5)
    v_dot2c_f32_bf16 v59, v92, v12
    v_dot2c_f32_bf16 v59, v93, v14
    v_dot2c_f32_bf16 v59, v94, v16
    v_dot2c_f32_bf16 v59, v95, v18
    s_cbranch_vccnz L_xt7
    s_waitcnt vmcnt(3)
L_xt7:
    buffer_load_dwordx4 v[108:111], v1, s[8:11], s58 offen offset:3072 nt
    buffer_load_dwordx4 v[136:139], v4, s[20:23], s75 offen
    v_add_f32_dpp v58, v58, v58 row_ror:8 row_mask:0xf bank_mask:0x3
    s_nop 1
    v_add_f32_dpp v58, v59, v59 row_ror:8 row_mask:0xf bank_mask:0xc
    v_add_f32_dpp v60, v56, v56 row_half_mirror row_mask:0xf bank_mask:0x5
    s_nop 1
    v_add_f32_dpp v60, v58, v58 row_half_mirror row_mask:0xf bank_mask:0xa
    v_mov_b32 v56, 0
    s_waitcnt vmcnt(5)
    v_dot2c_f32_bf16 v56, v96, v12
    v_dot2c_f32_bf16 v56, v97, v14
    v_dot2c_f32_bf16 v56, v98, v16
    v_dot2c_f32_bf16 v56, v99, v18
    s_cbranch_vccnz L_xt8
    s_waitcnt vmcnt(4)
L_xt8:
    s_mov_b32 s58, 327680
    buffer_load_dwordx4 v[112:115], v1, s[8:11], s58 offen offset:0 nt
    v_mov_b32 v57, 0
    s_waitcnt vmcnt(5)
    v_dot2c_f32_bf16 v57, v100, v12
    v_dot2c_f32_bf16 v57, v101, v14
    v_dot2c_f32_bf16 v57, v102, v16
    v_dot2c_f32_bf16 v57, v103, v18
    buffer_load_dwordx4 v[116:119], v1, s[8:11], s58 offen offset:1024 nt
    s_add_u32 s101, s99, 1
    s_and_b32 s101, s101, 15
    s_mul_i32 s101, s101, 896
    s_add_u32 s101, s101, s97
    buffer_load_dwordx4 v[132:135], v3, s[20:23], s101 offen
    v_add_f32_dpp v56, v56, v56 row_ror:8 row_mask:0xf bank_mask:0x3
    s_nop 1
    v_add_f32_dpp v56, v57, v57 row_ror:8 row_mask:0xf bank_mask:0xc
    v_mov_b32 v58, 0
    s_waitcnt vmcnt(5)
    v_dot2c_f32_bf16 v58, v104, v12
    v_dot2c_f32_bf16 v58, v105, v14
    v_dot2c_f32_bf16 v58, v106, v16
    v_dot2c_f32_bf16 v58, v107, v18
    s_cbranch_vccnz L_xt9
    s_waitcnt vmcnt(4)
L_xt9:
    buffer_load_dwordx4 v[120:123], v1, s[8:11], s58 offen offset:2048 nt
    v_mov_b32 v59, 0
    s_waitcnt vmcnt(5)
    v_dot2c_f32_bf16 v59, v108, v12
    v_dot2c_f32_bf16 v59, v109, v14
    v_dot2c_f32_bf16 v59, v110, v16
    v_dot2c_f32_bf16 v59, v111, v18
    buffer_load_dwordx4 v[124:127], v1, s[8:11], s58 offen offset:3072 nt
    s_mov_b32 s58, 360448
    buffer_load_dwordx4 v[64:67], v1, s[8:11], s58 offen offset:0 nt
    buffer_load_dwordx4 v[140:143], v4, s[20:23], s101 offen
    buffer_load_dwordx4 v[68:71], v1, s[8:11], s58 offen offset:1024 nt
    s_barrier
    v_add_f32_dpp v58, v58, v58 row_ror:8 row_mask:0xf bank_mask:0x3
    s_nop 1
    v_add_f32_dpp v58, v59, v59 row_ror:8 row_mask:0xf bank_mask:0xc
    v_add_f32_dpp v61, v56, v56 row_half_mirror row_mask:0xf bank_mask:0x5
    s_nop 1
    v_add_f32_dpp v61, v58, v58 row_half_mirror row_mask:0xf bank_mask:0xa
    v_add_f32_dpp v60, v60, v60 quad_perm:[2,3,0,1] row_mask:0xf bank_mask:0xf
    s_nop 0
    v_add_f32_dpp v61, v61, v61 quad_perm:[2,3,0,1] row_mask:0xf bank_mask:0xf
    v_cndmask_b32 v62, v60, v61, s[66:67]
    v_mov_b32 v56, 0
    s_waitcnt vmcnt(7)
    v_dot2c_f32_bf16 v56, v112, v12
    v_dot2c_f32_bf16 v56, v113, v14
    v_dot2c_f32_bf16 v56, v114, v16
    v_dot2c_f32_bf16 v56, v115, v18
    v_mov_b32 v57, 0
    s_waitcnt vmcnt(6)
    v_dot2c_f32_bf16 v57, v116, v12
    v_dot2c_f32_bf16 v57, v117, v14
    v_dot2c_f32_bf16 v57, v118, v16
    v_dot2c_f32_bf16 v57, v119, v18
    v_add_f32_dpp v56, v56, v56 row_ror:8 row_mask:0xf bank_mask:0x3
    s_nop 1
    v_add_f32_dpp v56, v57, v57 row_ror:8 row_mask:0xf bank_mask:0xc
    v_mov_b32 v58, 0
    s_waitcnt vmcnt(4)
    v_dot2c_f32_bf16 v58, v120, v12
    v_dot2c_f32_bf16 v58, v121, v14
    v_dot2c_f32_bf16 v58, v122, v16
    v_dot2c_f32_bf16 v58, v123, v18
    s_cbranch_vccnz L_xt10
    s_waitcnt vmcnt(3)
L_xt10:
    buffer_load_dwordx4 v[72:75], v1, s[8:11], s58 offen offset:2048 nt
    s_add_u32 s75, s99, 2
    s_and_b32 s75, s75, 15
    s_mul_i32 s75, s75, 896
    s_add_u32 s75, s75, s97
    buffer_load_dwordx4 v[144:147], v3, s[20:23], s75 offen
    v_mov_b32 v59, 0
    s_waitcnt vmcnt(5)
    v_dot2c_f32_bf16 v59, v124, v12
    v_dot2c_f32_bf16 v59, v125, v14
    v_dot2c_f32_bf16 v59, v126, v16
    v_dot2c_f32_bf16 v59, v127, v18
    buffer_load_dwordx4 v[76:79], v1, s[8:11], s58 offen offset:3072 nt
    v_add_f32_dpp v58, v58, v58 row_ror:8 row_mask:0xf bank_mask:0x3
    s_nop 1
    v_add_f32_dpp v58, v59, v59 row_ror:8 row_mask:0xf bank_mask:0xc
    v_add_f32_dpp v60, v56, v56 row_half_mirror row_mask:0xf bank_mask:0x5
    s_nop 1
    v_add_f32_dpp v60, v58, v58 row_half_mirror row_mask:0xf bank_mask:0xa
    v_mov_b32 v56, 0
    s_waitcnt vmcnt(5)
    v_dot2c_f32_bf16 v56, v64, v12
    v_dot2c_f32_bf16 v56, v65, v14
    v_dot2c_f32_bf16 v56, v66, v16
    v_dot2c_f32_bf16 v56, v67, v18
    s_cbranch_vccnz L_xt11
    s_waitcnt vmcnt(3)
L_xt11:
    s_mov_b32 s58, 393216
    buffer_load_dwordx4 v[80:83], v1, s[8:11], s58 offen offset:0 nt
    buffer_load_dwordx4 v[152:155], v4, s[20:23], s75 offen
    v_mov_b32 v57, 0
    s_waitcnt vmcnt(5)
    v_dot2c_f32_bf16 v57, v68, v12
    v_dot2c_f32_bf16 v57, v69, v14
    v_dot2c_f32_bf16 v57, v70, v16
    v_dot2c_f32_bf16 v57, v71, v18
    s_cbranch_vccnz L_xt12
    s_waitcnt vmcnt(4)
L_xt12:
    buffer_load_dwordx4 v[84:87], v1, s[8:11], s58 offen offset:1024 nt
    v_add_f32_dpp v56, v56, v56 row_ror:8 row_mask:0xf bank_mask:0x3
    s_nop 1
    v_add_f32_dpp v56, v57, v57 row_ror:8 row_mask:0xf bank_mask:0xc
    v_mov_b32 v58, 0
    s_waitcnt vmcnt(5)
    v_dot2c_f32_bf16 v58, v72, v12
    v_dot2c_f32_bf16 v58, v73, v14
    v_dot2c_f32_bf16 v58, v74, v16
    v_dot2c_f32_bf16 v58, v75, v18
    buffer_load_dwordx4 v[88:91], v1, s[8:11], s58 offen offset:2048 nt
    v_mov_b32 v59, 0
    s_waitcnt vmcnt(4)
    v_dot2c_f32_bf16 v59, v76, v12
    v_dot2c_f32_bf16 v59, v77, v14
    v_dot2c_f32_bf16 v59, v78, v16
    v_dot2c_f32_bf16 v59, v79, v18
    buffer_load_dwordx4 v[92:95], v1, s[8:11], s58 offen offset:3072 nt
    s_add_u32 s101, s99, 3
    s_and_b32 s101, s101, 15
    s_mul_i32 s101, s101, 896
    s_add_u32 s101, s101, s97
    buffer_load_dwordx4 v[148:151], v3, s[20:23], s101 offen
    s_mov_b32 s58, 425984
    buffer_load_dwordx4 v[96:99], v1, s[8:11], s58 offen offset:0 nt
    buffer_load_dwordx4 v[100:103], v1, s[8:11], s58 offen offset:1024 nt
    buffer_load_dwordx4 v[156:159], v4, s[20:23], s101 offen
    buffer_load_dwordx4 v[104:107], v1, s[8:11], s58 offen offset:2048 nt
    buffer_load_dwordx4 v[108:111], v1, s[8:11], s58 offen offset:3072 nt
    s_add_u32 s75, s99, 4
    s_and_b32 s75, s75, 15
    s_mul_i32 s75, s75, 896
    s_add_u32 s75, s75, s97
    buffer_load_dwordx4 v[160:163], v3, s[20:23], s75 offen
    v_add_f32_dpp v58, v58, v58 row_ror:8 row_mask:0xf bank_mask:0x3
    s_nop 1
    v_add_f32_dpp v58, v59, v59 row_ror:8 row_mask:0xf bank_mask:0xc
    v_add_f32_dpp v61, v56, v56 row_half_mirror row_mask:0xf bank_mask:0x5
    s_nop 1
    v_add_f32_dpp v61, v58, v58 row_half_mirror row_mask:0xf bank_mask:0xa
    v_add_f32_dpp v60, v60, v60 quad_perm:[2,3,0,1] row_mask:0xf bank_mask:0xf
    s_nop 0
    v_add_f32_dpp v61, v61, v61 quad_perm:[2,3,0,1] row_mask:0xf bank_mask:0xf
    v_cndmask_b32 v63, v60, v61, s[66:67]
    v_add_f32_dpp v62, v62, v62 quad_perm:[1,0,3,2] row_mask:0xf bank_mask:0xf
    s_nop 0
    v_add_f32_dpp v63, v63, v63 quad_perm:[1,0,3,2] row_mask:0xf bank_mask:0xf
    v_cndmask_b32 v22, v62, v63, s[68:69]
    v_mov_b32 v62, v22
    s_nop 1
    v_permlane16_swap_b32 v22, v62
    v_add_f32 v22, v22, v62
    v_cvt_pk_bf16_f32 v22, v22, v22
    v_and_b32 v22, 0xffff0000, v22
    s_lshl_b32 s7, s100, 4
    v_add_u32 v36, s7, v45
    ds_read_u16 v24, v36 offset:10432
    s_add_u32 s100, s100, 1
    s_cmp_eq_u32 s100, 7
    s_cselect_b32 s100, 0, s100
    s_lshl_b32 s7, s100, 4
    v_add_u32 v36, s7, v45
    ds_read_u16 v25, v36 offset:10432
    s_add_u32 s100, s100, 1
    s_cmp_eq_u32 s100, 7
    s_cselect_b32 s100, 0, s100
    s_lshl_b32 s7, s100, 4
    v_add_u32 v36, s7, v45
    ds_read_u16 v26, v36 offset:10432
    s_add_u32 s100, s100, 1
    s_cmp_eq_u32 s100, 7
    s_cselect_b32 s100, 0, s100
    s_lshl_b32 s7, s100, 4
    v_add_u32 v36, s7, v45
    ds_read_u16 v27, v36 offset:10432
    s_add_u32 s100, s100, 1
    s_cmp_eq_u32 s100, 7
    s_cselect_b32 s100, 0, s100
    s_lshl_b32 s7, s100, 4
    v_add_u32 v36, s7, v45
    ds_read_u16 v28, v36 offset:10432
    s_add_u32 s100, s100, 1
    s_cmp_eq_u32 s100, 7
    s_cselect_b32 s100, 0, s100
    s_lshl_b32 s7, s100, 4
    v_add_u32 v36, s7, v45
    ds_read_u16 v29, v36 offset:10432
    s_add_u32 s100, s100, 1
    s_cmp_eq_u32 s100, 7
    s_cselect_b32 s100, 0, s100
    s_lshl_b32 s7, s100, 4
    v_add_u32 v36, s7, v45
    ds_read_u16 v30, v36 offset:10432
    s_add_u32 s100, s100, 1
    s_cmp_eq_u32 s100, 7
    s_cselect_b32 s100, 0, s100
    v_mov_b32 v32, 0
    v_mov_b32 v33, 0
    v_mov_b32 v34, 0
    v_mov_b32 v35, 0
    s_waitcnt lgkmcnt(0)
    v_lshlrev_b32 v40, 16, v24
    v_dot2c_f32_bf16 v32, v224, v24
    v_dot2c_f32_bf16 v34, v225, v24
    v_dot2c_f32_bf16 v33, v224, v40
    v_dot2c_f32_bf16 v35, v225, v40
    v_lshlrev_b32 v41, 16, v25
    v_dot2c_f32_bf16 v32, v226, v25
    v_dot2c_f32_bf16 v34, v227, v25
    v_dot2c_f32_bf16 v33, v226, v41
    v_dot2c_f32_bf16 v35, v227, v41
    v_lshlrev_b32 v40, 16, v26
    v_dot2c_f32_bf16 v32, v228, v26
    v_dot2c_f32_bf16 v34, v229, v26
    v_dot2c_f32_bf16 v33, v228, v40
    v_dot2c_f32_bf16 v35, v229, v40
    v_lshlrev_b32 v41, 16, v27
    v_dot2c_f32_bf16 v32, v230, v27
    v_dot2c_f32_bf16 v34, v231, v27
    v_dot2c_f32_bf16 v33, v230, v41
    v_dot2c_f32_bf16 v35, v231, v41
    v_lshlrev_b32 v40, 16, v28
    v_dot2c_f32_bf16 v32, v232, v28
    v_dot2c_f32_bf16 v34, v233, v28
    v_dot2c_f32_bf16 v33, v232, v40
    v_dot2c_f32_bf16 v35, v233, v40
    v_lshlrev_b32 v41, 16, v29
    v_dot2c_f32_bf16 v32, v234, v29
    v_dot2c_f32_bf16 v34, v235, v29
    v_dot2c_f32_bf16 v33, v234, v41
    v_dot2c_f32_bf16 v35, v235, v41
    v_lshlrev_b32 v40, 16, v30
    v_dot2c_f32_bf16 v32, v236, v30
    v_dot2c_f32_bf16 v34, v237, v30
    v_dot2c_f32_bf16 v33, v236, v40
    v_dot2c_f32_bf16 v35, v237, v40
    s_nop 1
    v_permlane32_swap_b32 v32, v33
    v_permlane32_swap_b32 v34, v35
    v_add_f32 v32, v32, v33
    v_add_f32 v34, v34, v35
    s_nop 1
    v_permlane16_swap_b32 v32, v34
    v_add_f32 v32, v32, v34
    s_nop 1
    v_add_f32_dpp v32, v32, v32 row_ror:8 row_mask:0xf bank_mask:0xf
    ds_write_b32 v48, v32 offset:11520
    v_mov_b32 v40, 0
    v_mov_b32 v41, 1
    s_mov_b64 exec, 1
    ds_add_u32 v40, v41 offset:11456
    s_mov_b64 exec, -1
    v_mov_b32 v56, 0
    s_waitcnt vmcnt(11)
    v_dot2c_f32_bf16 v56, v80, v12
    v_dot2c_f32_bf16 v56, v81, v14
    v_dot2c_f32_bf16 v56, v82, v16
    v_dot2c_f32_bf16 v56, v83, v18
    v_mov_b32 v57, 0
    s_waitcnt vmcnt(9)
    v_dot2c_f32_bf16 v57, v84, v12
    v_dot2c_f32_bf16 v57, v85, v14
    v_dot2c_f32_bf16 v57, v86, v16
    v_dot2c_f32_bf16 v57, v87, v18
    v_add_f32_dpp v56, v56, v56 row_ror:8 row_mask:0xf bank_mask:0x3
    s_nop 1
    v_add_f32_dpp v56, v57, v57 row_ror:8 row_mask:0xf bank_mask:0xc
    v_mov_b32 v58, 0
    s_waitcnt vmcnt(8)
    v_dot2c_f32_bf16 v58, v88, v12
    v_dot2c_f32_bf16 v58, v89, v14
    v_dot2c_f32_bf16 v58, v90, v16
    v_dot2c_f32_bf16 v58, v91, v18
    v_mov_b32 v59, 0
    s_waitcnt vmcnt(7)
    v_dot2c_f32_bf16 v59, v92, v12
    v_dot2c_f32_bf16 v59, v93, v14
    v_dot2c_f32_bf16 v59, v94, v16
    v_dot2c_f32_bf16 v59, v95, v18
    v_add_f32_dpp v58, v58, v58 row_ror:8 row_mask:0xf bank_mask:0x3
    s_nop 1
    v_add_f32_dpp v58, v59, v59 row_ror:8 row_mask:0xf bank_mask:0xc
    v_add_f32_dpp v60, v56, v56 row_half_mirror row_mask:0xf bank_mask:0x5
    s_nop 1
    v_add_f32_dpp v60, v58, v58 row_half_mirror row_mask:0xf bank_mask:0xa
    v_mov_b32 v56, 0
    s_waitcnt vmcnt(5)
    v_dot2c_f32_bf16 v56, v96, v12
    v_dot2c_f32_bf16 v56, v97, v14
    v_dot2c_f32_bf16 v56, v98, v16
    v_dot2c_f32_bf16 v56, v99, v18
    s_mov_b32 s58, 458752
    buffer_load_dwordx4 v[112:115], v1, s[8:11], s58 offen offset:0 nt
    v_mov_b32 v57, 0
    s_waitcnt vmcnt(5)
    v_dot2c_f32_bf16 v57, v100, v12
    v_dot2c_f32_bf16 v57, v101, v14
    v_dot2c_f32_bf16 v57, v102, v16
    v_dot2c_f32_bf16 v57, v103, v18
    s_cbranch_vccnz L_xt13
    s_waitcnt vmcnt(3)
L_xt13:
    buffer_load_dwordx4 v[116:119], v1, s[8:11], s58 offen offset:1024 nt
    v_add_f32_dpp v56, v56, v56 row_ror:8 row_mask:0xf bank_mask:0x3
    s_nop 1
    v_add_f32_dpp v56, v57, v57 row_ror:8 row_mask:0xf bank_mask:0xc
    v_mov_b32 v58, 0
    s_waitcnt vmcnt(4)
    v_dot2c_f32_bf16 v58, v104, v12
    v_dot2c_f32_bf16 v58, v105, v14
    v_dot2c_f32_bf16 v58, v106, v16
    v_dot2c_f32_bf16 v58, v107, v18
    s_cbranch_vccnz L_xt14
    s_waitcnt vmcnt(3)
L_xt14:
    buffer_load_dwordx4 v[120:123], v1, s[8:11], s58 offen offset:2048 nt
    buffer_load_dwordx4 v[168:171], v4, s[20:23], s75 offen
    v_mov_b32 v59, 0
    s_waitcnt vmcnt(5)
    v_dot2c_f32_bf16 v59, v108, v12
    v_dot2c_f32_bf16 v59, v109, v14
    v_dot2c_f32_bf16 v59, v110, v16
    v_dot2c_f32_bf16 v59, v111, v18
    buffer_load_dwordx4 v[124:127], v1, s[8:11], s58 offen offset:3072 nt
    v_add_f32_dpp v58, v58, v58 row_ror:8 row_mask:0xf bank_mask:0x3
    s_nop 1
    v_add_f32_dpp v58, v59, v59 row_ror:8 row_mask:0xf bank_mask:0xc
    v_add_f32_dpp v61, v56, v56 row_half_mirror row_mask:0xf bank_mask:0x5
    s_nop 1
    v_add_f32_dpp v61, v58, v58 row_half_mirror row_mask:0xf bank_mask:0xa
    v_add_f32_dpp v60, v60, v60 quad_perm:[2,3,0,1] row_mask:0xf bank_mask:0xf
    s_nop 0
    v_add_f32_dpp v61, v61, v61 quad_perm:[2,3,0,1] row_mask:0xf bank_mask:0xf
    v_cndmask_b32 v62, v60, v61, s[66:67]
    v_mov_b32 v56, 0
    s_waitcnt vmcnt(4)
    v_dot2c_f32_bf16 v56, v112, v12
    v_dot2c_f32_bf16 v56, v113, v14
    v_dot2c_f32_bf16 v56, v114, v16
    v_dot2c_f32_bf16 v56, v115, v18
    s_cbranch_vccnz L_xt15
    s_waitcnt vmcnt(3)
L_xt15:
    s_mov_b32 s58, 491520
    buffer_load_dwordx4 v[64:67], v1, s[8:11], s58 offen offset:0 nt
    s_add_u32 s101, s99, 5
    s_and_b32 s101, s101, 15
    s_mul_i32 s101, s101, 896
    s_add_u32 s101, s101, s97
    buffer_load_dwordx4 v[164:167], v3, s[20:23], s101 offen
    v_mov_b32 v57, 0
    s_waitcnt vmcnt(5)
    v_dot2c_f32_bf16 v57, v116, v12
    v_dot2c_f32_bf16 v57, v117, v14
    v_dot2c_f32_bf16 v57, v118, v16
    v_dot2c_f32_bf16 v57, v119, v18
    s_cbranch_vccnz L_xt16
    s_waitcnt vmcnt(4)
L_xt16:
    buffer_load_dwordx4 v[68:71], v1, s[8:11], s58 offen offset:1024 nt
    v_add_f32_dpp v56, v56, v56 row_ror:8 row_mask:0xf bank_mask:0x3
    s_nop 1
    v_add_f32_dpp v56, v57, v57 row_ror:8 row_mask:0xf bank_mask:0xc
    v_mov_b32 v58, 0
    s_waitcnt vmcnt(5)
    v_dot2c_f32_bf16 v58, v120, v12
    v_dot2c_f32_bf16 v58, v121, v14
    v_dot2c_f32_bf16 v58, v122, v16
    v_dot2c_f32_bf16 v58, v123, v18
    buffer_load_dwordx4 v[72:75], v1, s[8:11], s58 offen offset:2048 nt
    buffer_load_dwordx4 v[172:175], v4, s[20:23], s101 offen
    v_mov_b32 v59, 0
    s_waitcnt vmcnt(5)
    v_dot2c_f32_bf16 v59, v124, v12
    v_dot2c_f32_bf16 v59, v125, v14
    v_dot2c_f32_bf16 v59, v126, v16
    v_dot2c_f32_bf16 v59, v127, v18
    s_cbranch_vccnz L_xt17
    s_waitcnt vmcnt(4)
L_xt17:
    buffer_load_dwordx4 v[76:79], v1, s[8:11], s58 offen offset:3072 nt
    v_add_f32_dpp v58, v58, v58 row_ror:8 row_mask:0xf bank_mask:0x3
    s_nop 1
    v_add_f32_dpp v58, v59, v59 row_ror:8 row_mask:0xf bank_mask:0xc
    v_add_f32_dpp v60, v56, v56 row_half_mirror row_mask:0xf bank_mask:0x5
    s_nop 1
    v_add_f32_dpp v60, v58, v58 row_half_mirror row_mask:0xf bank_mask:0xa
    v_mov_b32 v56, 0
    s_waitcnt vmcnt(5)
    v_dot2c_f32_bf16 v56, v64, v12
    v_dot2c_f32_bf16 v56, v65, v14
    v_dot2c_f32_bf16 v56, v66, v16
    v_dot2c_f32_bf16 v56, v67, v18
    s_cbranch_vccnz L_xt18
    s_waitcnt vmcnt(3)
L_xt18:
    s_mov_b32 s58, 0
    buffer_load_dwordx4 v[80:83], v1, s[12:15], s58 offen offset:0 nt
    s_add_u32 s75, s99, 6
    s_and_b32 s75, s75, 15
    s_mul_i32 s75, s75, 896
    s_add_u32 s75, s75, s97
    buffer_load_dwordx4 v[176:179], v3, s[20:23], s75 offen
    v_mov_b32 v57, 0
    s_waitcnt vmcnt(5)
    v_dot2c_f32_bf16 v57, v68, v12
    v_dot2c_f32_bf16 v57, v69, v14
    v_dot2c_f32_bf16 v57, v70, v16
    v_dot2c_f32_bf16 v57, v71, v18
    buffer_load_dwordx4 v[84:87], v1, s[12:15], s58 offen offset:1024 nt
    v_add_f32_dpp v56, v56, v56 row_ror:8 row_mask:0xf bank_mask:0x3
    s_nop 1
    v_add_f32_dpp v56, v57, v57 row_ror:8 row_mask:0xf bank_mask:0xc
    v_mov_b32 v58, 0
    s_waitcnt vmcnt(5)
    v_dot2c_f32_bf16 v58, v72, v12
    v_dot2c_f32_bf16 v58, v73, v14
    v_dot2c_f32_bf16 v58, v74, v16
    v_dot2c_f32_bf16 v58, v75, v18
    s_cbranch_vccnz L_xt19
    s_waitcnt vmcnt(3)
L_xt19:
    buffer_load_dwordx4 v[88:91], v1, s[12:15], s58 offen offset:2048 nt
    v_mov_b32 v59, 0
    s_waitcnt vmcnt(4)
    v_dot2c_f32_bf16 v59, v76, v12
    v_dot2c_f32_bf16 v59, v77, v14
    v_dot2c_f32_bf16 v59, v78, v16
    v_dot2c_f32_bf16 v59, v79, v18
    buffer_load_dwordx4 v[92:95], v1, s[12:15], s58 offen offset:3072 nt
    buffer_load_dwordx4 v[184:187], v4, s[20:23], s75 offen
    s_mov_b32 s58, 32768
    buffer_load_dwordx4 v[96:99], v1, s[12:15], s58 offen offset:0 nt
    buffer_load_dwordx4 v[100:103], v1, s[12:15], s58 offen offset:1024 nt
    s_add_u32 s101, s99, 7
    s_and_b32 s101, s101, 15
    s_mul_i32 s101, s101, 896
    s_add_u32 s101, s101, s97
    buffer_load_dwordx4 v[180:183], v3, s[20:23], s101 offen
    buffer_load_dwordx4 v[104:107], v1, s[12:15], s58 offen offset:2048 nt
    buffer_load_dwordx4 v[108:111], v1, s[12:15], s58 offen offset:3072 nt
    buffer_load_dwordx4 v[188:191], v4, s[20:23], s101 offen
    s_barrier
    v_add_f32_dpp v58, v58, v58 row_ror:8 row_mask:0xf bank_mask:0x3
    s_nop 1
    v_add_f32_dpp v58, v59, v59 row_ror:8 row_mask:0xf bank_mask:0xc
    v_add_f32_dpp v61, v56, v56 row_half_mirror row_mask:0xf bank_mask:0x5
    s_nop 1
    v_add_f32_dpp v61, v58, v58 row_half_mirror row_mask:0xf bank_mask:0xa
    v_add_f32_dpp v60, v60, v60 quad_perm:[2,3,0,1] row_mask:0xf bank_mask:0xf
    s_nop 0
    v_add_f32_dpp v61, v61, v61 quad_perm:[2,3,0,1] row_mask:0xf bank_mask:0xf
    v_cndmask_b32 v63, v60, v61, s[66:67]
    v_add_f32_dpp v62, v62, v62 quad_perm:[1,0,3,2] row_mask:0xf bank_mask:0xf
    s_nop 0
    v_add_f32_dpp v63, v63, v63 quad_perm:[1,0,3,2] row_mask:0xf bank_mask:0xf
    v_cndmask_b32 v23, v62, v63, s[68:69]
    v_mov_b32 v62, v23
    s_nop 1
    v_permlane16_swap_b32 v23, v62
    v_add_f32 v23, v23, v62
    v_cvt_pk_bf16_f32 v23, v23, v23
    v_and_b32 v23, 0xffff0000, v23
    v_max3_f32 v56, v20, v21, v22
    v_max_f32 v56, v56, v23
    s_nop 1
    v_max_f32_dpp v56, v56, v56 row_ror:8 row_mask:0xf bank_mask:0xf
    s_nop 1
    v_max_f32_dpp v56, v56, v56 row_ror:4 row_mask:0xf bank_mask:0xf
    s_nop 1
    v_max_f32_dpp v56, v56, v56 row_ror:2 row_mask:0xf bank_mask:0xf
    s_nop 1
    v_max_f32_dpp v56, v56, v56 row_ror:1 row_mask:0xf bank_mask:0xf
    v_mov_b32 v57, v56
    s_nop 1
    v_permlane32_swap_b32 v56, v57
    v_max_f32 v56, v56, v57
    v_mul_f32 v56, s72, v56
    v_fma_f32 v20, v20, s72, -v56
    v_fma_f32 v21, v21, s72, -v56
    v_fma_f32 v22, v22, s72, -v56
    v_fma_f32 v23, v23, s72, -v56
    v_exp_f32 v20, v20
    v_exp_f32 v21, v21
    v_exp_f32 v22, v22
    v_exp_f32 v23, v23
    v_add_f32 v58, v20, v21
    v_add_f32 v59, v22, v23
    v_add_f32 v58, v58, v59
    v_cvt_pk_bf16_f32 v20, v20, v20
    v_cvt_pk_bf16_f32 v21, v21, v21
    v_cvt_pk_bf16_f32 v22, v22, v22
    v_cvt_pk_bf16_f32 v23, v23, v23
    v_add_f32_dpp v58, v58, v58 row_ror:8 row_mask:0xf bank_mask:0xf
    s_nop 1
    v_add_f32_dpp v58, v58, v58 row_ror:4 row_mask:0xf bank_mask:0xf
    s_nop 1
    v_add_f32_dpp v58, v58, v58 row_ror:2 row_mask:0xf bank_mask:0xf
    s_nop 1
    v_add_f32_dpp v58, v58, v58 row_ror:1 row_mask:0xf bank_mask:0xf
    v_mov_b32 v59, v58
    s_nop 1
    v_permlane32_swap_b32 v58, v59
    v_add_f32 v58, v58, v59
    s_lshl_b32 s57, s3, 2
    v_mov_b32 v59, s57
    ds_write_b32 v59, v56 offset:10368
    ds_write_b32 v59, v58 offset:10400
    v_mov_b32 v45, v56
    v_mov_b32 v60, 0
L_cw1:
    ds_read_b32 v61, v60 offset:11456
    s_waitcnt lgkmcnt(0)
    v_readfirstlane_b32 s76, v61
    s_cmp_lt_u32 s76, 8
    s_cbranch_scc1 L_cw1
    ds_read_b32 v56, v55 offset:11520
    ds_read_b32 v57, v55 offset:11648
    ds_read_b32 v58, v55 offset:11776
    ds_read_b32 v59, v55 offset:11904
    v_lshlrev_b32 v51, 16, v51
    s_waitcnt lgkmcnt(0)
    v_add_f32 v56, v56, v57
    v_add_f32 v58, v58, v59
    v_add_f32 v56, v56, v58
    v_mov_b32 v57, v56
    s_nop 1
    v_permlane16_swap_b32 v56, v57
    v_add_f32 v56, v56, v57
    v_cvt_pk_bf16_f32 v56, v56, v56
    v_and_b32 v56, 0xffff0000, v56
    v_add_f32 v56, v56, v51
    v_cvt_pk_bf16_f32 v56, v56, v56
    v_and_b32 v56, 0xffff0000, v56
    v_max_f32 v56, 0, v56
    v_mul_f32 v56, v56, v56
    v_cvt_pk_bf16_f32 v47, v56, v56
    s_nop 1
    v_and_b32_dpp v56, v47, v6 row_newbcast:0 row_mask:0xf bank_mask:0xf
    v_and_b32_dpp v57, v47, v7 row_newbcast:0 row_mask:0xf bank_mask:0xf
    v_and_b32_dpp v58, v47, v8 row_newbcast:0 row_mask:0xf bank_mask:0xf
    v_and_b32_dpp v59, v47, v9 row_newbcast:0 row_mask:0xf bank_mask:0xf
    s_nop 1
    v_mfma_f32_16x16x32_bf16 v[36:39], v[56:59], v[240:243], 0
    v_mfma_f32_16x16x32_bf16 v[40:43], v[56:59], v[244:247], 0
    v_and_b32_dpp v60, v47, v6 row_newbcast:1 row_mask:0xf bank_mask:0xf
    v_and_b32_dpp v61, v47, v7 row_newbcast:1 row_mask:0xf bank_mask:0xf
    v_and_b32_dpp v62, v47, v8 row_newbcast:1 row_mask:0xf bank_mask:0xf
    v_and_b32_dpp v63, v47, v9 row_newbcast:1 row_mask:0xf bank_mask:0xf
    s_nop 1
    v_mfma_f32_16x16x32_bf16 v[36:39], v[60:63], v[248:251], v[36:39]
    v_mfma_f32_16x16x32_bf16 v[40:43], v[60:63], v[252:255], v[40:43]
    s_nop 6
    ds_write_b128 v53, v[36:39] offset:12544
    ds_write_b128 v53, v[40:43] offset:13568
    v_mov_b32 v56, 0
    v_mov_b32 v57, 1
    s_mov_b64 exec, 1
    ds_add_u32 v56, v57 offset:11460
    s_mov_b64 exec, -1
    v_mov_b32 v55, v49
    v_and_b32_dpp v24, v20, v6 row_newbcast:0 row_mask:0xf bank_mask:0xf
    v_and_b32_dpp v25, v20, v7 row_newbcast:0 row_mask:0xf bank_mask:0xf
    v_and_b32_dpp v26, v20, v8 row_newbcast:0 row_mask:0xf bank_mask:0xf
    v_and_b32_dpp v27, v20, v9 row_newbcast:0 row_mask:0xf bank_mask:0xf
    s_waitcnt vmcnt(11)
    s_nop 0
    v_mfma_f32_16x16x32_bf16 v[32:35], v[24:27], v[80:83], 0
    v_and_b32_dpp v28, v20, v6 row_newbcast:8 row_mask:0xf bank_mask:0xf
    v_and_b32_dpp v29, v20, v7 row_newbcast:8 row_mask:0xf bank_mask:0xf
    v_and_b32_dpp v30, v20, v8 row_newbcast:8 row_mask:0xf bank_mask:0xf
    v_and_b32_dpp v31, v20, v9 row_newbcast:8 row_mask:0xf bank_mask:0xf
    s_waitcnt vmcnt(9)
    s_nop 0
    v_mfma_f32_16x16x32_bf16 v[32:35], v[28:31], v[84:87], v[32:35]
    v_and_b32_dpp v24, v20, v6 row_newbcast:4 row_mask:0xf bank_mask:0xf
    v_and_b32_dpp v25, v20, v7 row_newbcast:4 row_mask:0xf bank_mask:0xf
    v_and_b32_dpp v26, v20, v8 row_newbcast:4 row_mask:0xf bank_mask:0xf
    v_and_b32_dpp v27, v20, v9 row_newbcast:4 row_mask:0xf bank_mask:0xf
    s_waitcnt vmcnt(8)
    s_nop 0
    v_mfma_f32_16x16x32_bf16 v[32:35], v[24:27], v[88:91], v[32:35]
    v_and_b32_dpp v28, v20, v6 row_newbcast:12 row_mask:0xf bank_mask:0xf
    v_and_b32_dpp v29, v20, v7 row_newbcast:12 row_mask:0xf bank_mask:0xf
    v_and_b32_dpp v30, v20, v8 row_newbcast:12 row_mask:0xf bank_mask:0xf
    v_and_b32_dpp v31, v20, v9 row_newbcast:12 row_mask:0xf bank_mask:0xf
    s_waitcnt vmcnt(7)
    s_nop 0
    v_mfma_f32_16x16x32_bf16 v[32:35], v[28:31], v[92:95], v[32:35]
    v_and_b32_dpp v24, v20, v6 row_newbcast:2 row_mask:0xf bank_mask:0xf
    v_and_b32_dpp v25, v20, v7 row_newbcast:2 row_mask:0xf bank_mask:0xf
    v_and_b32_dpp v26, v20, v8 row_newbcast:2 row_mask:0xf bank_mask:0xf
    v_and_b32_dpp v27, v20, v9 row_newbcast:2 row_mask:0xf bank_mask:0xf
    s_waitcnt vmcnt(5)
    s_nop 0
    v_mfma_f32_16x16x32_bf16 v[32:35], v[24:27], v[96:99], v[32:35]
    s_cbranch_vccnz L_xt20
    s_waitcnt vmcnt(4)
L_xt20:
    s_mov_b32 s58, 65536
    buffer_load_dwordx4 v[112:115], v1, s[12:15], s58 offen offset:0 nt
    v_and_b32_dpp v28, v20, v6 row_newbcast:10 row_mask:0xf bank_mask:0xf
    v_and_b32_dpp v29, v20, v7 row_newbcast:10 row_mask:0xf bank_mask:0xf
    v_and_b32_dpp v30, v20, v8 row_newbcast:10 row_mask:0xf bank_mask:0xf
    v_and_b32_dpp v31, v20, v9 row_newbcast:10 row_mask:0xf bank_mask:0xf
    s_waitcnt vmcnt(5)
    s_nop 0
    v_mfma_f32_16x16x32_bf16 v[32:35], v[28:31], v[100:103], v[32:35]
    s_cbranch_vccnz L_xt21
    s_waitcnt vmcnt(3)
L_xt21:
    buffer_load_dwordx4 v[64:67], v1, s[12:15], s58 offen offset:1024 nt
    v_and_b32_dpp v24, v20, v6 row_newbcast:6 row_mask:0xf bank_mask:0xf
    v_and_b32_dpp v25, v20, v7 row_newbcast:6 row_mask:0xf bank_mask:0xf
    v_and_b32_dpp v26, v20, v8 row_newbcast:6 row_mask:0xf bank_mask:0xf
    v_and_b32_dpp v27, v20, v9 row_newbcast:6 row_mask:0xf bank_mask:0xf
    s_waitcnt vmcnt(4)
    s_nop 0
    v_mfma_f32_16x16x32_bf16 v[32:35], v[24:27], v[104:107], v[32:35]
    buffer_load_dwordx4 v[68:71], v1, s[12:15], s58 offen offset:2048 nt
    s_add_u32 s75, s99, 8
    s_and_b32 s75, s75, 15
    s_mul_i32 s75, s75, 896
    s_add_u32 s75, s75, s97
    buffer_load_dwordx4 v[192:195], v3, s[20:23], s75 offen
    v_and_b32_dpp v28, v20, v6 row_newbcast:14 row_mask:0xf bank_mask:0xf
    v_and_b32_dpp v29, v20, v7 row_newbcast:14 row_mask:0xf bank_mask:0xf
    v_and_b32_dpp v30, v20, v8 row_newbcast:14 row_mask:0xf bank_mask:0xf
    v_and_b32_dpp v31, v20, v9 row_newbcast:14 row_mask:0xf bank_mask:0xf
    s_waitcnt vmcnt(5)
    s_nop 0
    v_mfma_f32_16x16x32_bf16 v[32:35], v[28:31], v[108:111], v[32:35]
    s_cbranch_vccnz L_xt22
    s_waitcnt vmcnt(3)
L_xt22:
    buffer_load_dwordx4 v[72:75], v1, s[12:15], s58 offen offset:3072 nt
    v_and_b32_dpp v24, v20, v6 row_newbcast:1 row_mask:0xf bank_mask:0xf
    v_and_b32_dpp v25, v20, v7 row_newbcast:1 row_mask:0xf bank_mask:0xf
    v_and_b32_dpp v26, v20, v8 row_newbcast:1 row_mask:0xf bank_mask:0xf
    v_and_b32_dpp v27, v20, v9 row_newbcast:1 row_mask:0xf bank_mask:0xf
    s_waitcnt vmcnt(4)
    s_nop 0
    v_mfma_f32_16x16x32_bf16 v[32:35], v[24:27], v[112:115], v[32:35]
    s_cbranch_vccnz L_xt23
    s_waitcnt vmcnt(3)
L_xt23:
    s_mov_b32 s58, 98304
    buffer_load_dwordx4 v[76:79], v1, s[12:15], s58 offen offset:0 nt
    buffer_load_dwordx4 v[200:203], v4, s[20:23], s75 offen
    v_and_b32_dpp v28, v20, v6 row_newbcast:9 row_mask:0xf bank_mask:0xf
    v_and_b32_dpp v29, v20, v7 row_newbcast:9 row_mask:0xf bank_mask:0xf
    v_and_b32_dpp v30, v20, v8 row_newbcast:9 row_mask:0xf bank_mask:0xf
    v_and_b32_dpp v31, v20, v9 row_newbcast:9 row_mask:0xf bank_mask:0xf
    s_waitcnt vmcnt(5)
    s_nop 0
    v_mfma_f32_16x16x32_bf16 v[32:35], v[28:31], v[64:67], v[32:35]
    buffer_load_dwordx4 v[80:83], v1, s[12:15], s58 offen offset:1024 nt
    v_and_b32_dpp v24, v20, v6 row_newbcast:5 row_mask:0xf bank_mask:0xf
    v_and_b32_dpp v25, v20, v7 row_newbcast:5 row_mask:0xf bank_mask:0xf
    v_and_b32_dpp v26, v20, v8 row_newbcast:5 row_mask:0xf bank_mask:0xf
    v_and_b32_dpp v27, v20, v9 row_newbcast:5 row_mask:0xf bank_mask:0xf
    s_waitcnt vmcnt(5)
    s_nop 0
    v_mfma_f32_16x16x32_bf16 v[32:35], v[24:27], v[68:71], v[32:35]
    s_cbranch_vccnz L_xt24
    s_waitcnt vmcnt(3)
L_xt24:
    buffer_load_dwordx4 v[84:87], v1, s[12:15], s58 offen offset:2048 nt
    s_add_u32 s101, s99, 9
    s_and_b32 s101, s101, 15
    s_mul_i32 s101, s101, 896
    s_add_u32 s101, s101, s97
    buffer_load_dwordx4 v[196:199], v3, s[20:23], s101 offen
    v_and_b32_dpp v28, v20, v6 row_newbcast:13 row_mask:0xf bank_mask:0xf
    v_and_b32_dpp v29, v20, v7 row_newbcast:13 row_mask:0xf bank_mask:0xf
    v_and_b32_dpp v30, v20, v8 row_newbcast:13 row_mask:0xf bank_mask:0xf
    v_and_b32_dpp v31, v20, v9 row_newbcast:13 row_mask:0xf bank_mask:0xf
    s_waitcnt vmcnt(5)
    s_nop 0
    v_mfma_f32_16x16x32_bf16 v[32:35], v[28:31], v[72:75], v[32:35]
    s_cbranch_vccnz L_xt25
    s_waitcnt vmcnt(4)
L_xt25:
    buffer_load_dwordx4 v[88:91], v1, s[12:15], s58 offen offset:3072 nt
    v_and_b32_dpp v24, v20, v6 row_newbcast:3 row_mask:0xf bank_mask:0xf
    v_and_b32_dpp v25, v20, v7 row_newbcast:3 row_mask:0xf bank_mask:0xf
    v_and_b32_dpp v26, v20, v8 row_newbcast:3 row_mask:0xf bank_mask:0xf
    v_and_b32_dpp v27, v20, v9 row_newbcast:3 row_mask:0xf bank_mask:0xf
    s_waitcnt vmcnt(5)
    s_nop 0
    v_mfma_f32_16x16x32_bf16 v[32:35], v[24:27], v[76:79], v[32:35]
    s_mov_b32 s58, 131072
    buffer_load_dwordx4 v[92:95], v1, s[12:15], s58 offen offset:0 nt
    v_and_b32_dpp v28, v20, v6 row_newbcast:11 row_mask:0xf bank_mask:0xf
    v_and_b32_dpp v29, v20, v7 row_newbcast:11 row_mask:0xf bank_mask:0xf
    v_and_b32_dpp v30, v20, v8 row_newbcast:11 row_mask:0xf bank_mask:0xf
    v_and_b32_dpp v31, v20, v9 row_newbcast:11 row_mask:0xf bank_mask:0xf
    s_waitcnt vmcnt(4)
    s_nop 0
    v_mfma_f32_16x16x32_bf16 v[32:35], v[28:31], v[80:83], v[32:35]
    s_cbranch_vccnz L_xt26
    s_waitcnt vmcnt(3)
L_xt26:
    buffer_load_dwordx4 v[96:99], v1, s[12:15], s58 offen offset:1024 nt
    buffer_load_dwordx4 v[204:207], v4, s[20:23], s101 offen
    v_and_b32_dpp v24, v20, v6 row_newbcast:7 row_mask:0xf bank_mask:0xf
    v_and_b32_dpp v25, v20, v7 row_newbcast:7 row_mask:0xf bank_mask:0xf
    v_and_b32_dpp v26, v20, v8 row_newbcast:7 row_mask:0xf bank_mask:0xf
    v_and_b32_dpp v27, v20, v9 row_newbcast:7 row_mask:0xf bank_mask:0xf
    s_waitcnt vmcnt(5)
    s_nop 0
    v_mfma_f32_16x16x32_bf16 v[32:35], v[24:27], v[84:87], v[32:35]
    s_cbranch_vccnz L_xt27
    s_waitcnt vmcnt(3)
L_xt27:
    buffer_load_dwordx4 v[100:103], v1, s[12:15], s58 offen offset:2048 nt
    v_and_b32_dpp v28, v20, v6 row_newbcast:15 row_mask:0xf bank_mask:0xf
    v_and_b32_dpp v29, v20, v7 row_newbcast:15 row_mask:0xf bank_mask:0xf
    v_and_b32_dpp v30, v20, v8 row_newbcast:15 row_mask:0xf bank_mask:0xf
    v_and_b32_dpp v31, v20, v9 row_newbcast:15 row_mask:0xf bank_mask:0xf
    s_waitcnt vmcnt(4)
    s_nop 0
    v_mfma_f32_16x16x32_bf16 v[32:35], v[28:31], v[88:91], v[32:35]
    buffer_load_dwordx4 v[104:107], v1, s[12:15], s58 offen offset:3072 nt
    s_add_u32 s75, s99, 10
    s_and_b32 s75, s75, 15
    s_mul_i32 s75, s75, 896
    s_add_u32 s75, s75, s97
    buffer_load_dwordx4 v[208:211], v3, s[20:23], s75 offen
    v_and_b32_dpp v24, v21, v6 row_newbcast:0 row_mask:0xf bank_mask:0xf
    v_and_b32_dpp v25, v21, v7 row_newbcast:0 row_mask:0xf bank_mask:0xf
    v_and_b32_dpp v26, v21, v8 row_newbcast:0 row_mask:0xf bank_mask:0xf
    v_and_b32_dpp v27, v21, v9 row_newbcast:0 row_mask:0xf bank_mask:0xf
    s_waitcnt vmcnt(5)
    s_nop 0
    v_mfma_f32_16x16x32_bf16 v[32:35], v[24:27], v[92:95], v[32:35]
    s_cbranch_vccnz L_xt28
    s_waitcnt vmcnt(4)
L_xt28:
    s_mov_b32 s58, 163840
    buffer_load_dwordx4 v[108:111], v1, s[12:15], s58 offen offset:0 nt
    v_and_b32_dpp v28, v21, v6 row_newbcast:8 row_mask:0xf bank_mask:0xf
    v_and_b32_dpp v29, v21, v7 row_newbcast:8 row_mask:0xf bank_mask:0xf
    v_and_b32_dpp v30, v21, v8 row_newbcast:8 row_mask:0xf bank_mask:0xf
    v_and_b32_dpp v31, v21, v9 row_newbcast:8 row_mask:0xf bank_mask:0xf
    s_waitcnt vmcnt(5)
    s_nop 0
    v_mfma_f32_16x16x32_bf16 v[32:35], v[28:31], v[96:99], v[32:35]
    s_cbranch_vccnz L_xt29
    s_waitcnt vmcnt(3)
L_xt29:
    buffer_load_dwordx4 v[112:115], v1, s[12:15], s58 offen offset:1024 nt
    buffer_load_dwordx4 v[216:219], v4, s[20:23], s75 offen
    v_and_b32_dpp v24, v21, v6 row_newbcast:4 row_mask:0xf bank_mask:0xf
    v_and_b32_dpp v25, v21, v7 row_newbcast:4 row_mask:0xf bank_mask:0xf
    v_and_b32_dpp v26, v21, v8 row_newbcast:4 row_mask:0xf bank_mask:0xf
    v_and_b32_dpp v27, v21, v9 row_newbcast:4 row_mask:0xf bank_mask:0xf
    s_waitcnt vmcnt(5)
    s_nop 0
    v_mfma_f32_16x16x32_bf16 v[32:35], v[24:27], v[100:103], v[32:35]
    buffer_load_dwordx4 v[64:67], v1, s[12:15], s58 offen offset:2048 nt
    v_and_b32_dpp v28, v21, v6 row_newbcast:12 row_mask:0xf bank_mask:0xf
    v_and_b32_dpp v29, v21, v7 row_newbcast:12 row_mask:0xf bank_mask:0xf
    v_and_b32_dpp v30, v21, v8 row_newbcast:12 row_mask:0xf bank_mask:0xf
    v_and_b32_dpp v31, v21, v9 row_newbcast:12 row_mask:0xf bank_mask:0xf
    s_waitcnt vmcnt(5)
    s_nop 0
    v_mfma_f32_16x16x32_bf16 v[32:35], v[28:31], v[104:107], v[32:35]
    s_cbranch_vccnz L_xt30
    s_waitcnt vmcnt(3)
L_xt30:
    buffer_load_dwordx4 v[68:71], v1, s[12:15], s58 offen offset:3072 nt
    s_add_u32 s101, s99, 11
    s_and_b32 s101, s101, 15
    s_mul_i32 s101, s101, 896
    s_add_u32 s101, s101, s97
    buffer_load_dwordx4 v[212:215], v3, s[20:23], s101 offen
    v_and_b32_dpp v24, v21, v6 row_newbcast:2 row_mask:0xf bank_mask:0xf
    v_and_b32_dpp v25, v21, v7 row_newbcast:2 row_mask:0xf bank_mask:0xf
    v_and_b32_dpp v26, v21, v8 row_newbcast:2 row_mask:0xf bank_mask:0xf
    v_and_b32_dpp v27, v21, v9 row_newbcast:2 row_mask:0xf bank_mask:0xf
    s_waitcnt vmcnt(5)
    s_nop 0
    v_mfma_f32_16x16x32_bf16 v[32:35], v[24:27], v[108:111], v[32:35]
    s_cbranch_vccnz L_xt31
    s_waitcnt vmcnt(4)
L_xt31:
    s_mov_b32 s58, 196608
    buffer_load_dwordx4 v[72:75], v1, s[12:15], s58 offen offset:0 nt
    v_and_b32_dpp v28, v21, v6 row_newbcast:10 row_mask:0xf bank_mask:0xf
    v_and_b32_dpp v29, v21, v7 row_newbcast:10 row_mask:0xf bank_mask:0xf
    v_and_b32_dpp v30, v21, v8 row_newbcast:10 row_mask:0xf bank_mask:0xf
    v_and_b32_dpp v31, v21, v9 row_newbcast:10 row_mask:0xf bank_mask:0xf
    s_waitcnt vmcnt(5)
    s_nop 0
    v_mfma_f32_16x16x32_bf16 v[32:35], v[28:31], v[112:115], v[32:35]
    buffer_load_dwordx4 v[76:79], v1, s[12:15], s58 offen offset:1024 nt
    v_and_b32_dpp v24, v21, v6 row_newbcast:6 row_mask:0xf bank_mask:0xf
    v_and_b32_dpp v25, v21, v7 row_newbcast:6 row_mask:0xf bank_mask:0xf
    v_and_b32_dpp v26, v21, v8 row_newbcast:6 row_mask:0xf bank_mask:0xf
    v_and_b32_dpp v27, v21, v9 row_newbcast:6 row_mask:0xf bank_mask:0xf
    s_waitcnt vmcnt(4)
    s_nop 0
    v_mfma_f32_16x16x32_bf16 v[32:35], v[24:27], v[64:67], v[32:35]
    s_cbranch_vccnz L_xt32
    s_waitcnt vmcnt(3)
L_xt32:
    buffer_load_dwordx4 v[80:83], v1, s[12:15], s58 offen offset:2048 nt
    buffer_load_dwordx4 v[220:223], v4, s[20:23], s101 offen
    v_and_b32_dpp v28, v21, v6 row_newbcast:14 row_mask:0xf bank_mask:0xf
    v_and_b32_dpp v29, v21, v7 row_newbcast:14 row_mask:0xf bank_mask:0xf
    v_and_b32_dpp v30, v21, v8 row_newbcast:14 row_mask:0xf bank_mask:0xf
    v_and_b32_dpp v31, v21, v9 row_newbcast:14 row_mask:0xf bank_mask:0xf
    s_waitcnt vmcnt(5)
    s_nop 0
    v_mfma_f32_16x16x32_bf16 v[32:35], v[28:31], v[68:71], v[32:35]
    buffer_load_dwordx4 v[84:87], v1, s[12:15], s58 offen offset:3072 nt
    s_mov_b32 s58, 229376
    buffer_load_dwordx4 v[88:91], v1, s[12:15], s58 offen offset:0 nt
    s_add_u32 s75, s99, 12
    s_and_b32 s75, s75, 15
    s_mul_i32 s75, s75, 896
    s_add_u32 s75, s75, s97
    buffer_load_dwordx4 v[224:227], v3, s[20:23], s75 offen
    buffer_load_dwordx4 v[92:95], v1, s[12:15], s58 offen offset:1024 nt
    s_barrier
    v_and_b32_dpp v24, v21, v6 row_newbcast:1 row_mask:0xf bank_mask:0xf
    v_and_b32_dpp v25, v21, v7 row_newbcast:1 row_mask:0xf bank_mask:0xf
    v_and_b32_dpp v26, v21, v8 row_newbcast:1 row_mask:0xf bank_mask:0xf
    v_and_b32_dpp v27, v21, v9 row_newbcast:1 row_mask:0xf bank_mask:0xf
    s_waitcnt vmcnt(7)
    s_nop 0
    v_mfma_f32_16x16x32_bf16 v[32:35], v[24:27], v[72:75], v[32:35]
    v_and_b32_dpp v28, v21, v6 row_newbcast:9 row_mask:0xf bank_mask:0xf
    v_and_b32_dpp v29, v21, v7 row_newbcast:9 row_mask:0xf bank_mask:0xf
    v_and_b32_dpp v30, v21, v8 row_newbcast:9 row_mask:0xf bank_mask:0xf
    v_and_b32_dpp v31, v21, v9 row_newbcast:9 row_mask:0xf bank_mask:0xf
    s_waitcnt vmcnt(6)
    s_nop 0
    v_mfma_f32_16x16x32_bf16 v[32:35], v[28:31], v[76:79], v[32:35]
    v_and_b32_dpp v24, v21, v6 row_newbcast:5 row_mask:0xf bank_mask:0xf
    v_and_b32_dpp v25, v21, v7 row_newbcast:5 row_mask:0xf bank_mask:0xf
    v_and_b32_dpp v26, v21, v8 row_newbcast:5 row_mask:0xf bank_mask:0xf
    v_and_b32_dpp v27, v21, v9 row_newbcast:5 row_mask:0xf bank_mask:0xf
    s_waitcnt vmcnt(5)
    s_nop 0
    v_mfma_f32_16x16x32_bf16 v[32:35], v[24:27], v[80:83], v[32:35]
    s_cbranch_vccnz L_xt33
    s_waitcnt vmcnt(3)
L_xt33:
    buffer_load_dwordx4 v[96:99], v1, s[12:15], s58 offen offset:2048 nt
    buffer_load_dwordx4 v[232:235], v4, s[20:23], s75 offen
    v_and_b32_dpp v28, v21, v6 row_newbcast:13 row_mask:0xf bank_mask:0xf
    v_and_b32_dpp v29, v21, v7 row_newbcast:13 row_mask:0xf bank_mask:0xf
    v_and_b32_dpp v30, v21, v8 row_newbcast:13 row_mask:0xf bank_mask:0xf
    v_and_b32_dpp v31, v21, v9 row_newbcast:13 row_mask:0xf bank_mask:0xf
    s_waitcnt vmcnt(5)
    s_nop 0
    v_mfma_f32_16x16x32_bf16 v[32:35], v[28:31], v[84:87], v[32:35]
    buffer_load_dwordx4 v[100:103], v1, s[12:15], s58 offen offset:3072 nt
    v_and_b32_dpp v24, v21, v6 row_newbcast:3 row_mask:0xf bank_mask:0xf
    v_and_b32_dpp v25, v21, v7 row_newbcast:3 row_mask:0xf bank_mask:0xf
    v_and_b32_dpp v26, v21, v8 row_newbcast:3 row_mask:0xf bank_mask:0xf
    v_and_b32_dpp v27, v21, v9 row_newbcast:3 row_mask:0xf bank_mask:0xf
    s_waitcnt vmcnt(5)
    s_nop 0
    v_mfma_f32_16x16x32_bf16 v[32:35], v[24:27], v[88:91], v[32:35]
    s_cbranch_vccnz L_xt34
    s_waitcnt vmcnt(3)
L_xt34:
    s_mov_b32 s58, 262144
    buffer_load_dwordx4 v[104:107], v1, s[12:15], s58 offen offset:0 nt
    v_and_b32_dpp v28, v21, v6 row_newbcast:11 row_mask:0xf bank_mask:0xf
    v_and_b32_dpp v29, v21, v7 row_newbcast:11 row_mask:0xf bank_mask:0xf
    v_and_b32_dpp v30, v21, v8 row_newbcast:11 row_mask:0xf bank_mask:0xf
    v_and_b32_dpp v31, v21, v9 row_newbcast:11 row_mask:0xf bank_mask:0xf
    s_waitcnt vmcnt(4)
    s_nop 0
    v_mfma_f32_16x16x32_bf16 v[32:35], v[28:31], v[92:95], v[32:35]
    s_cbranch_vccnz L_xt35
    s_waitcnt vmcnt(3)
L_xt35:
    buffer_load_dwordx4 v[108:111], v1, s[12:15], s58 offen offset:1024 nt
    s_add_u32 s101, s99, 13
    s_and_b32 s101, s101, 15
    s_mul_i32 s101, s101, 896
    s_add_u32 s101, s101, s97
    buffer_load_dwordx4 v[228:231], v3, s[20:23], s101 offen
    v_and_b32_dpp v24, v21, v6 row_newbcast:7 row_mask:0xf bank_mask:0xf
    v_and_b32_dpp v25, v21, v7 row_newbcast:7 row_mask:0xf bank_mask:0xf
    v_and_b32_dpp v26, v21, v8 row_newbcast:7 row_mask:0xf bank_mask:0xf
    v_and_b32_dpp v27, v21, v9 row_newbcast:7 row_mask:0xf bank_mask:0xf
    s_waitcnt vmcnt(5)
    s_nop 0
    v_mfma_f32_16x16x32_bf16 v[32:35], v[24:27], v[96:99], v[32:35]
    buffer_load_dwordx4 v[112:115], v1, s[12:15], s58 offen offset:2048 nt
    v_and_b32_dpp v28, v21, v6 row_newbcast:15 row_mask:0xf bank_mask:0xf
    v_and_b32_dpp v29, v21, v7 row_newbcast:15 row_mask:0xf bank_mask:0xf
    v_and_b32_dpp v30, v21, v8 row_newbcast:15 row_mask:0xf bank_mask:0xf
    v_and_b32_dpp v31, v21, v9 row_newbcast:15 row_mask:0xf bank_mask:0xf
    s_waitcnt vmcnt(4)
    s_nop 0
    v_mfma_f32_16x16x32_bf16 v[32:35], v[28:31], v[100:103], v[32:35]
    s_cbranch_vccnz L_xt36
    s_waitcnt vmcnt(3)
L_xt36:
    buffer_load_dwordx4 v[64:67], v1, s[12:15], s58 offen offset:3072 nt
    buffer_load_dwordx4 v[236:239], v4, s[20:23], s101 offen
    v_and_b32_dpp v24, v22, v6 row_newbcast:0 row_mask:0xf bank_mask:0xf
    v_and_b32_dpp v25, v22, v7 row_newbcast:0 row_mask:0xf bank_mask:0xf
    v_and_b32_dpp v26, v22, v8 row_newbcast:0 row_mask:0xf bank_mask:0xf
    v_and_b32_dpp v27, v22, v9 row_newbcast:0 row_mask:0xf bank_mask:0xf
    s_waitcnt vmcnt(5)
    s_nop 0
    v_mfma_f32_16x16x32_bf16 v[32:35], v[24:27], v[104:107], v[32:35]
    s_cbranch_vccnz L_xt37
    s_waitcnt vmcnt(4)
L_xt37:
    s_mov_b32 s58, 294912
    buffer_load_dwordx4 v[68:71], v1, s[12:15], s58 offen offset:0 nt
    v_and_b32_dpp v28, v22, v6 row_newbcast:8 row_mask:0xf bank_mask:0xf
    v_and_b32_dpp v29, v22, v7 row_newbcast:8 row_mask:0xf bank_mask:0xf
    v_and_b32_dpp v30, v22, v8 row_newbcast:8 row_mask:0xf bank_mask:0xf
    v_and_b32_dpp v31, v22, v9 row_newbcast:8 row_mask:0xf bank_mask:0xf
    s_waitcnt vmcnt(5)
    s_nop 0
    v_mfma_f32_16x16x32_bf16 v[32:35], v[28:31], v[108:111], v[32:35]
    buffer_load_dwordx4 v[72:75], v1, s[12:15], s58 offen offset:1024 nt
    s_add_u32 s75, s99, 14
    s_and_b32 s75, s75, 15
    s_mul_i32 s75, s75, 896
    s_add_u32 s75, s75, s97
    buffer_load_dwordx4 v[240:243], v3, s[20:23], s75 offen
    v_and_b32_dpp v24, v22, v6 row_newbcast:4 row_mask:0xf bank_mask:0xf
    v_and_b32_dpp v25, v22, v7 row_newbcast:4 row_mask:0xf bank_mask:0xf
    v_and_b32_dpp v26, v22, v8 row_newbcast:4 row_mask:0xf bank_mask:0xf
    v_and_b32_dpp v27, v22, v9 row_newbcast:4 row_mask:0xf bank_mask:0xf
    s_waitcnt vmcnt(5)
    s_nop 0
    v_mfma_f32_16x16x32_bf16 v[32:35], v[24:27], v[112:115], v[32:35]
    s_cbranch_vccnz L_xt38
    s_waitcnt vmcnt(4)
L_xt38:
    buffer_load_dwordx4 v[76:79], v1, s[12:15], s58 offen offset:2048 nt
    v_and_b32_dpp v28, v22, v6 row_newbcast:12 row_mask:0xf bank_mask:0xf
    v_and_b32_dpp v29, v22, v7 row_newbcast:12 row_mask:0xf bank_mask:0xf
    v_and_b32_dpp v30, v22, v8 row_newbcast:12 row_mask:0xf bank_mask:0xf
    v_and_b32_dpp v31, v22, v9 row_newbcast:12 row_mask:0xf bank_mask:0xf
    s_waitcnt vmcnt(5)
    s_nop 0
    v_mfma_f32_16x16x32_bf16 v[32:35], v[28:31], v[64:67], v[32:35]
    s_cbranch_vccnz L_xt39
    s_waitcnt vmcnt(3)
L_xt39:
    buffer_load_dwordx4 v[80:83], v1, s[12:15], s58 offen offset:3072 nt
    v_and_b32_dpp v24, v22, v6 row_newbcast:2 row_mask:0xf bank_mask:0xf
    v_and_b32_dpp v25, v22, v7 row_newbcast:2 row_mask:0xf bank_mask:0xf
    v_and_b32_dpp v26, v22, v8 row_newbcast:2 row_mask:0xf bank_mask:0xf
    v_and_b32_dpp v27, v22, v9 row_newbcast:2 row_mask:0xf bank_mask:0xf
    s_waitcnt vmcnt(4)
    s_nop 0
    v_mfma_f32_16x16x32_bf16 v[32:35], v[24:27], v[68:71], v[32:35]
    s_mov_b32 s58, 327680
    buffer_load_dwordx4 v[84:87], v1, s[12:15], s58 offen offset:0 nt
    buffer_load_dwordx4 v[248:251], v4, s[20:23], s75 offen
    s_mov_b32 s73, 0x70000000
    s_cmp_eq_u32 s5, 0
    s_cbranch_scc1 L_skip_ra
    s_lshl_b32 s57, s55, 3
    v_add_u32 v56, s57, v50
    v_lshlrev_b32 v5, 1, v56
    buffer_load_ushort v49, v5, s[32:35], 0 offen
    buffer_load_ushort v50, v5, s[40:43], 0 offen
    v_mul_u32_u24 v52, 2688, v0
    s_mul_i32 s73, s54, 172032
    s_mul_i32 s57, s55, 48
    s_add_u32 s73, s73, s57
    s_add_u32 s73, s73, 131072
    s_mul_i32 s57, s54, 896
    v_add_u32 v5, s57, v5
L_skip_ra:
    v_and_b32_dpp v28, v22, v6 row_newbcast:10 row_mask:0xf bank_mask:0xf
    v_and_b32_dpp v29, v22, v7 row_newbcast:10 row_mask:0xf bank_mask:0xf
    v_and_b32_dpp v30, v22, v8 row_newbcast:10 row_mask:0xf bank_mask:0xf
    v_and_b32_dpp v31, v22, v9 row_newbcast:10 row_mask:0xf bank_mask:0xf
    s_waitcnt vmcnt(5)
    s_nop 0
    v_mfma_f32_16x16x32_bf16 v[32:35], v[28:31], v[72:75], v[32:35]
    s_cbranch_vccnz L_xt40
    s_waitcnt vmcnt(3)
L_xt40:
    buffer_load_dwordx4 v[88:91], v1, s[12:15], s58 offen offset:1024 nt
    v_and_b32_dpp v24, v22, v6 row_newbcast:6 row_mask:0xf bank_mask:0xf
    v_and_b32_dpp v25, v22, v7 row_newbcast:6 row_mask:0xf bank_mask:0xf
    v_and_b32_dpp v26, v22, v8 row_newbcast:6 row_mask:0xf bank_mask:0xf
    v_and_b32_dpp v27, v22, v9 row_newbcast:6 row_mask:0xf bank_mask:0xf
    s_waitcnt vmcnt(4)
    s_nop 0
    v_mfma_f32_16x16x32_bf16 v[32:35], v[24:27], v[76:79], v[32:35]
    s_cbranch_vccnz L_xt41
    s_waitcnt vmcnt(3)
L_xt41:
    buffer_load_dwordx4 v[92:95], v1, s[12:15], s58 offen offset:2048 nt
    s_add_u32 s101, s99, 15
    s_and_b32 s101, s101, 15
    s_mul_i32 s101, s101, 896
    s_add_u32 s101, s101, s97
    buffer_load_dwordx4 v[244:247], v3, s[20:23], s101 offen
    v_and_b32_dpp v28, v22, v6 row_newbcast:14 row_mask:0xf bank_mask:0xf
    v_and_b32_dpp v29, v22, v7 row_newbcast:14 row_mask:0xf bank_mask:0xf
    v_and_b32_dpp v30, v22, v8 row_newbcast:14 row_mask:0xf bank_mask:0xf
    v_and_b32_dpp v31, v22, v9 row_newbcast:14 row_mask:0xf bank_mask:0xf
    s_waitcnt vmcnt(5)
    s_nop 0
    v_mfma_f32_16x16x32_bf16 v[32:35], v[28:31], v[80:83], v[32:35]
    buffer_load_dwordx4 v[96:99], v1, s[12:15], s58 offen offset:3072 nt
    v_and_b32_dpp v24, v22, v6 row_newbcast:1 row_mask:0xf bank_mask:0xf
    v_and_b32_dpp v25, v22, v7 row_newbcast:1 row_mask:0xf bank_mask:0xf
    v_and_b32_dpp v26, v22, v8 row_newbcast:1 row_mask:0xf bank_mask:0xf
    v_and_b32_dpp v27, v22, v9 row_newbcast:1 row_mask:0xf bank_mask:0xf
    s_waitcnt vmcnt(5)
    s_nop 0
    v_mfma_f32_16x16x32_bf16 v[32:35], v[24:27], v[84:87], v[32:35]
    s_cbranch_vccnz L_xt42
    s_waitcnt vmcnt(3)
L_xt42:
    s_mov_b32 s58, 360448
    buffer_load_dwordx4 v[100:103], v1, s[12:15], s58 offen offset:0 nt
    buffer_load_dwordx4 v[252:255], v4, s[20:23], s101 offen
    v_and_b32_dpp v28, v22, v6 row_newbcast:9 row_mask:0xf bank_mask:0xf
    v_and_b32_dpp v29, v22, v7 row_newbcast:9 row_mask:0xf bank_mask:0xf
    v_and_b32_dpp v30, v22, v8 row_newbcast:9 row_mask:0xf bank_mask:0xf
    v_and_b32_dpp v31, v22, v9 row_newbcast:9 row_mask:0xf bank_mask:0xf
    s_waitcnt vmcnt(5)
    s_nop 0
    v_mfma_f32_16x16x32_bf16 v[32:35], v[28:31], v[88:91], v[32:35]
    s_cbranch_vccnz L_xt43
    s_waitcnt vmcnt(4)
L_xt43:
    buffer_load_dwordx4 v[104:107], v1, s[12:15], s58 offen offset:1024 nt
    v_and_b32_dpp v24, v22, v6 row_newbcast:5 row_mask:0xf bank_mask:0xf
    v_and_b32_dpp v25, v22, v7 row_newbcast:5 row_mask:0xf bank_mask:0xf
    v_and_b32_dpp v26, v22, v8 row_newbcast:5 row_mask:0xf bank_mask:0xf
    v_and_b32_dpp v27, v22, v9 row_newbcast:5 row_mask:0xf bank_mask:0xf
    s_waitcnt vmcnt(5)
    s_nop 0
    v_mfma_f32_16x16x32_bf16 v[32:35], v[24:27], v[92:95], v[32:35]
    buffer_load_dwordx4 v[108:111], v1, s[12:15], s58 offen offset:2048 nt
    v_and_b32_dpp v28, v22, v6 row_newbcast:13 row_mask:0xf bank_mask:0xf
    v_and_b32_dpp v29, v22, v7 row_newbcast:13 row_mask:0xf bank_mask:0xf
    v_and_b32_dpp v30, v22, v8 row_newbcast:13 row_mask:0xf bank_mask:0xf
    v_and_b32_dpp v31, v22, v9 row_newbcast:13 row_mask:0xf bank_mask:0xf
    s_waitcnt vmcnt(4)
    s_nop 0
    v_mfma_f32_16x16x32_bf16 v[32:35], v[28:31], v[96:99], v[32:35]
    buffer_load_dwordx4 v[112:115], v1, s[12:15], s58 offen offset:3072 nt
    s_mov_b32 s58, 393216
    buffer_load_dwordx4 v[64:67], v1, s[12:15], s58 offen offset:0 nt
    buffer_load_dwordx4 v[68:71], v1, s[12:15], s58 offen offset:1024 nt
    s_barrier
    v_and_b32_dpp v24, v22, v6 row_newbcast:3 row_mask:0xf bank_mask:0xf
    v_and_b32_dpp v25, v22, v7 row_newbcast:3 row_mask:0xf bank_mask:0xf
    v_and_b32_dpp v26, v22, v8 row_newbcast:3 row_mask:0xf bank_mask:0xf
    v_and_b32_dpp v27, v22, v9 row_newbcast:3 row_mask:0xf bank_mask:0xf
    s_waitcnt vmcnt(6)
    s_nop 0
    v_mfma_f32_16x16x32_bf16 v[32:35], v[24:27], v[100:103], v[32:35]
    v_and_b32_dpp v28, v22, v6 row_newbcast:11 row_mask:0xf bank_mask:0xf
    v_and_b32_dpp v29, v22, v7 row_newbcast:11 row_mask:0xf bank_mask:0xf
    v_and_b32_dpp v30, v22, v8 row_newbcast:11 row_mask:0xf bank_mask:0xf
    v_and_b32_dpp v31, v22, v9 row_newbcast:11 row_mask:0xf bank_mask:0xf
    s_waitcnt vmcnt(4)
    s_nop 0
    v_mfma_f32_16x16x32_bf16 v[32:35], v[28:31], v[104:107], v[32:35]
    v_and_b32_dpp v24, v22, v6 row_newbcast:7 row_mask:0xf bank_mask:0xf
    v_and_b32_dpp v25, v22, v7 row_newbcast:7 row_mask:0xf bank_mask:0xf
    v_and_b32_dpp v26, v22, v8 row_newbcast:7 row_mask:0xf bank_mask:0xf
    v_and_b32_dpp v27, v22, v9 row_newbcast:7 row_mask:0xf bank_mask:0xf
    s_waitcnt vmcnt(3)
    s_nop 0
    v_mfma_f32_16x16x32_bf16 v[32:35], v[24:27], v[108:111], v[32:35]
    s_cbranch_vccnz L_xt44
    s_waitcnt vmcnt(2)
L_xt44:
    buffer_load_dwordx4 v[72:75], v1, s[12:15], s58 offen offset:2048 nt
    v_and_b32_dpp v28, v22, v6 row_newbcast:15 row_mask:0xf bank_mask:0xf
    v_and_b32_dpp v29, v22, v7 row_newbcast:15 row_mask:0xf bank_mask:0xf
    v_and_b32_dpp v30, v22, v8 row_newbcast:15 row_mask:0xf bank_mask:0xf
    v_and_b32_dpp v31, v22, v9 row_newbcast:15 row_mask:0xf bank_mask:0xf
    s_waitcnt vmcnt(3)
    s_nop 0
    v_mfma_f32_16x16x32_bf16 v[32:35], v[28:31], v[112:115], v[32:35]
    s_cbranch_vccnz L_xt45
    s_waitcnt vmcnt(2)
L_xt45:
    buffer_load_dwordx4 v[76:79], v1, s[12:15], s58 offen offset:3072 nt
    v_and_b32_dpp v24, v23, v6 row_newbcast:0 row_mask:0xf bank_mask:0xf
    v_and_b32_dpp v25, v23, v7 row_newbcast:0 row_mask:0xf bank_mask:0xf
    v_and_b32_dpp v26, v23, v8 row_newbcast:0 row_mask:0xf bank_mask:0xf
    v_and_b32_dpp v27, v23, v9 row_newbcast:0 row_mask:0xf bank_mask:0xf
    s_waitcnt vmcnt(3)
    s_nop 0
    v_mfma_f32_16x16x32_bf16 v[32:35], v[24:27], v[64:67], v[32:35]
    s_mov_b32 s58, 425984
    buffer_load_dwordx4 v[80:83], v1, s[12:15], s58 offen offset:0 nt
    v_and_b32_dpp v28, v23, v6 row_newbcast:8 row_mask:0xf bank_mask:0xf
    v_and_b32_dpp v29, v23, v7 row_newbcast:8 row_mask:0xf bank_mask:0xf
    v_and_b32_dpp v30, v23, v8 row_newbcast:8 row_mask:0xf bank_mask:0xf
    v_and_b32_dpp v31, v23, v9 row_newbcast:8 row_mask:0xf bank_mask:0xf
    s_waitcnt vmcnt(3)
    s_nop 0
    v_mfma_f32_16x16x32_bf16 v[32:35], v[28:31], v[68:71], v[32:35]
    s_cbranch_vccnz L_xt46
    s_waitcnt vmcnt(2)
L_xt46:
    buffer_load_dwordx4 v[84:87], v1, s[12:15], s58 offen offset:1024 nt
    v_and_b32_dpp v24, v23, v6 row_newbcast:4 row_mask:0xf bank_mask:0xf
    v_and_b32_dpp v25, v23, v7 row_newbcast:4 row_mask:0xf bank_mask:0xf
    v_and_b32_dpp v26, v23, v8 row_newbcast:4 row_mask:0xf bank_mask:0xf
    v_and_b32_dpp v27, v23, v9 row_newbcast:4 row_mask:0xf bank_mask:0xf
    s_waitcnt vmcnt(3)
    s_nop 0
    v_mfma_f32_16x16x32_bf16 v[32:35], v[24:27], v[72:75], v[32:35]
    s_cbranch_vccnz L_xt47
    s_waitcnt vmcnt(2)
L_xt47:
    buffer_load_dwordx4 v[88:91], v1, s[12:15], s58 offen offset:2048 nt
    v_and_b32_dpp v28, v23, v6 row_newbcast:12 row_mask:0xf bank_mask:0xf
    v_and_b32_dpp v29, v23, v7 row_newbcast:12 row_mask:0xf bank_mask:0xf
    v_and_b32_dpp v30, v23, v8 row_newbcast:12 row_mask:0xf bank_mask:0xf
    v_and_b32_dpp v31, v23, v9 row_newbcast:12 row_mask:0xf bank_mask:0xf
    s_waitcnt vmcnt(3)
    s_nop 0
    v_mfma_f32_16x16x32_bf16 v[32:35], v[28:31], v[76:79], v[32:35]
    buffer_load_dwordx4 v[92:95], v1, s[12:15], s58 offen offset:3072 nt
    v_and_b32_dpp v24, v23, v6 row_newbcast:2 row_mask:0xf bank_mask:0xf
    v_and_b32_dpp v25, v23, v7 row_newbcast:2 row_mask:0xf bank_mask:0xf
    v_and_b32_dpp v26, v23, v8 row_newbcast:2 row_mask:0xf bank_mask:0xf
    v_and_b32_dpp v27, v23, v9 row_newbcast:2 row_mask:0xf bank_mask:0xf
    s_waitcnt vmcnt(3)
    s_nop 0
    v_mfma_f32_16x16x32_bf16 v[32:35], v[24:27], v[80:83], v[32:35]
    s_mov_b32 s58, 458752
    buffer_load_dwordx4 v[96:99], v1, s[12:15], s58 offen offset:0 nt
    buffer_load_dwordx4 v[100:103], v1, s[12:15], s58 offen offset:1024 nt
    buffer_load_dwordx4 v[104:107], v1, s[12:15], s58 offen offset:2048 nt
    buffer_load_dwordx4 v[108:111], v1, s[12:15], s58 offen offset:3072 nt
    s_mov_b32 s58, 491520
    buffer_load_dwordx4 v[112:115], v1, s[12:15], s58 offen offset:0 nt
    v_and_b32_dpp v28, v23, v6 row_newbcast:10 row_mask:0xf bank_mask:0xf
    v_and_b32_dpp v29, v23, v7 row_newbcast:10 row_mask:0xf bank_mask:0xf
    v_and_b32_dpp v30, v23, v8 row_newbcast:10 row_mask:0xf bank_mask:0xf
    v_and_b32_dpp v31, v23, v9 row_newbcast:10 row_mask:0xf bank_mask:0xf
    s_waitcnt vmcnt(7)
    s_nop 0
    v_mfma_f32_16x16x32_bf16 v[32:35], v[28:31], v[84:87], v[32:35]
    buffer_load_dwordx4 v[64:67], v1, s[12:15], s58 offen offset:1024 nt
    v_and_b32_dpp v24, v23, v6 row_newbcast:6 row_mask:0xf bank_mask:0xf
    v_and_b32_dpp v25, v23, v7 row_newbcast:6 row_mask:0xf bank_mask:0xf
    v_and_b32_dpp v26, v23, v8 row_newbcast:6 row_mask:0xf bank_mask:0xf
    v_and_b32_dpp v27, v23, v9 row_newbcast:6 row_mask:0xf bank_mask:0xf
    s_waitcnt vmcnt(7)
    s_nop 0
    v_mfma_f32_16x16x32_bf16 v[32:35], v[24:27], v[88:91], v[32:35]
    buffer_load_dwordx4 v[68:71], v1, s[12:15], s58 offen offset:2048 nt
    v_and_b32_dpp v28, v23, v6 row_newbcast:14 row_mask:0xf bank_mask:0xf
    v_and_b32_dpp v29, v23, v7 row_newbcast:14 row_mask:0xf bank_mask:0xf
    v_and_b32_dpp v30, v23, v8 row_newbcast:14 row_mask:0xf bank_mask:0xf
    v_and_b32_dpp v31, v23, v9 row_newbcast:14 row_mask:0xf bank_mask:0xf
    s_waitcnt vmcnt(7)
    s_nop 0
    v_mfma_f32_16x16x32_bf16 v[32:35], v[28:31], v[92:95], v[32:35]
    buffer_load_dwordx4 v[72:75], v1, s[12:15], s58 offen offset:3072 nt
    v_mov_b32 v60, 0
L_cw2:
    ds_read_b32 v61, v60 offset:11460
    s_waitcnt lgkmcnt(0)
    v_readfirstlane_b32 s76, v61
    s_cmp_lt_u32 s76, 8
    s_cbranch_scc1 L_cw2
    ds_read_b128 v[36:39], v10 offset:10368
    ds_read_b128 v[40:43], v10 offset:10400
    s_waitcnt lgkmcnt(0)
    v_max3_f32 v46, v36, v37, v38
    v_max_f32 v46, v46, v39
    v_mov_b32 v60, v46
    s_nop 1
    v_permlane16_swap_b32 v46, v60
    v_max_f32 v46, v46, v60
    v_sub_f32 v36, v36, v46
    v_sub_f32 v37, v37, v46
    v_sub_f32 v38, v38, v46
    v_sub_f32 v39, v39, v46
    v_sub_f32 v45, v45, v46
    v_exp_f32 v36, v36
    v_exp_f32 v37, v37
    v_exp_f32 v38, v38
    v_exp_f32 v39, v39
    v_exp_f32 v45, v45
    v_mul_f32 v56, v40, v36
    v_fmac_f32 v56, v41, v37
    v_fmac_f32 v56, v42, v38
    v_fmac_f32 v56, v43, v39
    v_mov_b32 v60, v56
    s_nop 1
    v_permlane16_swap_b32 v56, v60
    v_add_f32 v56, v56, v60
    v_log_f32 v60, v56
    v_rcp_f32 v56, v56
    v_add_f32 v46, v46, v60
    v_mul_f32 v45, v45, v56
    s_call_b64 s[90:91], L_pub
    s_nop 1
    v_mov_b32 v12, 0
    v_mov_b32 v13, 0
    v_mov_b32 v14, 0
    v_mov_b32 v15, 0
    v_mov_b32 v16, 0
    v_mov_b32 v17, 0
    v_mov_b32 v18, 0
    v_mov_b32 v19, 0
    v_mov_b32 v36, 0
    v_mov_b32 v37, 0
    v_mov_b32 v38, 0
    v_mov_b32 v39, 0
    v_mov_b32 v40, 0
    v_mov_b32 v41, 0
    v_mov_b32 v42, 0
    v_mov_b32 v43, 0
    v_and_b32 v51, 3, v0
    v_mul_u32_u24 v51, 0x5555, v51
    v_lshrrev_b32 v60, 3, v0
    v_mul_u32_u24 v60, 3024, v60
    v_add_u32 v44, v44, v60
    s_mul_i32 s63, s54, 172032
    s_mul_i32 s57, s55, 48
    s_add_u32 s63, s63, s57
    s_mul_i32 s57, s3, 24576
    s_add_u32 s63, s63, s57
    s_add_u32 s63, s63, 1048576
    v_and_b32_dpp v24, v23, v6 row_newbcast:1 row_mask:0xf bank_mask:0xf
    v_and_b32_dpp v25, v23, v7 row_newbcast:1 row_mask:0xf bank_mask:0xf
    v_and_b32_dpp v26, v23, v8 row_newbcast:1 row_mask:0xf bank_mask:0xf
    v_and_b32_dpp v27, v23, v9 row_newbcast:1 row_mask:0xf bank_mask:0xf
    s_waitcnt vmcnt(8)
    s_nop 0
    v_mfma_f32_16x16x32_bf16 v[32:35], v[24:27], v[96:99], v[32:35]
    v_and_b32_dpp v28, v23, v6 row_newbcast:9 row_mask:0xf bank_mask:0xf
    v_and_b32_dpp v29, v23, v7 row_newbcast:9 row_mask:0xf bank_mask:0xf
    v_and_b32_dpp v30, v23, v8 row_newbcast:9 row_mask:0xf bank_mask:0xf
    v_and_b32_dpp v31, v23, v9 row_newbcast:9 row_mask:0xf bank_mask:0xf
    s_waitcnt vmcnt(7)
    s_nop 0
    v_mfma_f32_16x16x32_bf16 v[32:35], v[28:31], v[100:103], v[32:35]
    v_and_b32_dpp v24, v23, v6 row_newbcast:5 row_mask:0xf bank_mask:0xf
    v_and_b32_dpp v25, v23, v7 row_newbcast:5 row_mask:0xf bank_mask:0xf
    v_and_b32_dpp v26, v23, v8 row_newbcast:5 row_mask:0xf bank_mask:0xf
    v_and_b32_dpp v27, v23, v9 row_newbcast:5 row_mask:0xf bank_mask:0xf
    s_waitcnt vmcnt(6)
    s_nop 0
    v_mfma_f32_16x16x32_bf16 v[32:35], v[24:27], v[104:107], v[32:35]
    v_and_b32_dpp v28, v23, v6 row_newbcast:13 row_mask:0xf bank_mask:0xf
    v_and_b32_dpp v29, v23, v7 row_newbcast:13 row_mask:0xf bank_mask:0xf
    v_and_b32_dpp v30, v23, v8 row_newbcast:13 row_mask:0xf bank_mask:0xf
    v_and_b32_dpp v31, v23, v9 row_newbcast:13 row_mask:0xf bank_mask:0xf
    s_waitcnt vmcnt(5)
    s_nop 0
    v_mfma_f32_16x16x32_bf16 v[32:35], v[28:31], v[108:111], v[32:35]
    v_and_b32_dpp v24, v23, v6 row_newbcast:3 row_mask:0xf bank_mask:0xf
    v_and_b32_dpp v25, v23, v7 row_newbcast:3 row_mask:0xf bank_mask:0xf
    v_and_b32_dpp v26, v23, v8 row_newbcast:3 row_mask:0xf bank_mask:0xf
    v_and_b32_dpp v27, v23, v9 row_newbcast:3 row_mask:0xf bank_mask:0xf
    s_waitcnt vmcnt(4)
    s_nop 0
    v_mfma_f32_16x16x32_bf16 v[32:35], v[24:27], v[112:115], v[32:35]
    v_and_b32_dpp v28, v23, v6 row_newbcast:11 row_mask:0xf bank_mask:0xf
    v_and_b32_dpp v29, v23, v7 row_newbcast:11 row_mask:0xf bank_mask:0xf
    v_and_b32_dpp v30, v23, v8 row_newbcast:11 row_mask:0xf bank_mask:0xf
    v_and_b32_dpp v31, v23, v9 row_newbcast:11 row_mask:0xf bank_mask:0xf
    s_waitcnt vmcnt(3)
    s_nop 0
    v_mfma_f32_16x16x32_bf16 v[32:35], v[28:31], v[64:67], v[32:35]
    v_and_b32_dpp v24, v23, v6 row_newbcast:7 row_mask:0xf bank_mask:0xf
    v_and_b32_dpp v25, v23, v7 row_newbcast:7 row_mask:0xf bank_mask:0xf
    v_and_b32_dpp v26, v23, v8 row_newbcast:7 row_mask:0xf bank_mask:0xf
    v_and_b32_dpp v27, v23, v9 row_newbcast:7 row_mask:0xf bank_mask:0xf
    s_waitcnt vmcnt(2)
    s_nop 0
    v_mfma_f32_16x16x32_bf16 v[32:35], v[24:27], v[68:71], v[32:35]
    v_and_b32_dpp v28, v23, v6 row_newbcast:15 row_mask:0xf bank_mask:0xf
    v_and_b32_dpp v29, v23, v7 row_newbcast:15 row_mask:0xf bank_mask:0xf
    v_and_b32_dpp v30, v23, v8 row_newbcast:15 row_mask:0xf bank_mask:0xf
    v_and_b32_dpp v31, v23, v9 row_newbcast:15 row_mask:0xf bank_mask:0xf
    s_waitcnt vmcnt(1)
    s_nop 0
    v_mfma_f32_16x16x32_bf16 v[32:35], v[28:31], v[72:75], v[32:35]
    buffer_load_dwordx4 v[116:119], v52, s[44:47], s73 offen offset:0 sc1
    buffer_load_dwordx4 v[120:123], v52, s[44:47], s73 offen offset:16 sc1
    buffer_load_dwordx4 v[124:127], v52, s[44:47], s73 offen offset:32 sc1
    s_nop 4
    v_mul_f32 v32, v32, v45
    v_mul_f32 v33, v33, v45
    v_mul_f32 v34, v34, v45
    v_mul_f32 v35, v35, v45
    ds_write_b128 v54, v[32:35] offset:0
    s_waitcnt lgkmcnt(0)
    s_barrier
    ds_read_b32 v56, v55 offset:0
    ds_read_b32 v57, v55 offset:1040
    ds_read_b32 v58, v55 offset:2080
    ds_read_b32 v59, v55 offset:3120
    s_waitcnt lgkmcnt(2)
    v_add_f32 v56, v56, v57
    s_waitcnt lgkmcnt(0)
    v_add_f32 v58, v58, v59
    v_add_f32 v56, v56, v58
    s_nop 1
    v_add_f32_dpp v56, v56, v56 row_ror:8 row_mask:0xf bank_mask:0xf
    v_cvt_pk_bf16_f32 v47, v56, 0
    s_nop 1
    v_mov_b32_dpp v12, v47 row_newbcast:0 row_mask:0xf bank_mask:0x1
    v_mov_b32_dpp v13, v47 row_newbcast:0 row_mask:0xf bank_mask:0x2
    v_mov_b32_dpp v14, v47 row_newbcast:0 row_mask:0xf bank_mask:0x4
    v_mov_b32_dpp v15, v47 row_newbcast:0 row_mask:0xf bank_mask:0x8
    v_mov_b32_dpp v16, v47 row_newbcast:1 row_mask:0xf bank_mask:0x1
    v_mov_b32_dpp v17, v47 row_newbcast:1 row_mask:0xf bank_mask:0x2
    v_mov_b32_dpp v18, v47 row_newbcast:1 row_mask:0xf bank_mask:0x4
    v_mov_b32_dpp v19, v47 row_newbcast:1 row_mask:0xf bank_mask:0x8
    v_smfmac_f32_16x16x64_bf16 v[36:39], v[12:15], v[128:135], v51
    v_smfmac_f32_16x16x64_bf16 v[40:43], v[12:15], v[136:143], v51
    v_mov_b32_dpp v12, v47 row_newbcast:2 row_mask:0xf bank_mask:0x1
    v_mov_b32_dpp v13, v47 row_newbcast:2 row_mask:0xf bank_mask:0x2
    v_mov_b32_dpp v14, v47 row_newbcast:2 row_mask:0xf bank_mask:0x4
    v_mov_b32_dpp v15, v47 row_newbcast:2 row_mask:0xf bank_mask:0x8
    v_smfmac_f32_16x16x64_bf16 v[36:39], v[16:19], v[144:151], v51
    v_smfmac_f32_16x16x64_bf16 v[40:43], v[16:19], v[152:159], v51
    v_mov_b32_dpp v16, v47 row_newbcast:3 row_mask:0xf bank_mask:0x1
    v_mov_b32_dpp v17, v47 row_newbcast:3 row_mask:0xf bank_mask:0x2
    v_mov_b32_dpp v18, v47 row_newbcast:3 row_mask:0xf bank_mask:0x4
    v_mov_b32_dpp v19, v47 row_newbcast:3 row_mask:0xf bank_mask:0x8
    v_smfmac_f32_16x16x64_bf16 v[36:39], v[12:15], v[160:167], v51
    v_smfmac_f32_16x16x64_bf16 v[40:43], v[12:15], v[168:175], v51
    v_mov_b32_dpp v12, v47 row_newbcast:4 row_mask:0xf bank_mask:0x1
    v_mov_b32_dpp v13, v47 row_newbcast:4 row_mask:0xf bank_mask:0x2
    v_mov_b32_dpp v14, v47 row_newbcast:4 row_mask:0xf bank_mask:0x4
    v_mov_b32_dpp v15, v47 row_newbcast:4 row_mask:0xf bank_mask:0x8
    v_smfmac_f32_16x16x64_bf16 v[36:39], v[16:19], v[176:183], v51
    v_smfmac_f32_16x16x64_bf16 v[40:43], v[16:19], v[184:191], v51
    v_mov_b32_dpp v16, v47 row_newbcast:5 row_mask:0xf bank_mask:0x1
    v_mov_b32_dpp v17, v47 row_newbcast:5 row_mask:0xf bank_mask:0x2
    v_mov_b32_dpp v18, v47 row_newbcast:5 row_mask:0xf bank_mask:0x4
    v_mov_b32_dpp v19, v47 row_newbcast:5 row_mask:0xf bank_mask:0x8
    v_smfmac_f32_16x16x64_bf16 v[36:39], v[12:15], v[192:199], v51
    v_smfmac_f32_16x16x64_bf16 v[40:43], v[12:15], v[200:207], v51
    v_mov_b32_dpp v12, v47 row_newbcast:6 row_mask:0xf bank_mask:0x1
    v_mov_b32_dpp v13, v47 row_newbcast:6 row_mask:0xf bank_mask:0x2
    v_mov_b32_dpp v14, v47 row_newbcast:6 row_mask:0xf bank_mask:0x4
    v_mov_b32_dpp v15, v47 row_newbcast:6 row_mask:0xf bank_mask:0x8
    v_smfmac_f32_16x16x64_bf16 v[36:39], v[16:19], v[208:215], v51
    v_smfmac_f32_16x16x64_bf16 v[40:43], v[16:19], v[216:223], v51
    v_mov_b32_dpp v16, v47 row_newbcast:7 row_mask:0xf bank_mask:0x1
    v_mov_b32_dpp v17, v47 row_newbcast:7 row_mask:0xf bank_mask:0x2
    v_mov_b32_dpp v18, v47 row_newbcast:7 row_mask:0xf bank_mask:0x4
    v_mov_b32_dpp v19, v47 row_newbcast:7 row_mask:0xf bank_mask:0x8
    v_smfmac_f32_16x16x64_bf16 v[36:39], v[12:15], v[224:231], v51
    v_smfmac_f32_16x16x64_bf16 v[40:43], v[12:15], v[232:239], v51
    v_smfmac_f32_16x16x64_bf16 v[36:39], v[16:19], v[240:247], v51
    v_smfmac_f32_16x16x64_bf16 v[40:43], v[16:19], v[248:255], v51
    s_nop 6
    ds_write_b128 v53, v[36:39] offset:12544
    ds_write_b128 v53, v[40:43] offset:13568
    s_waitcnt lgkmcnt(0)
    s_barrier
    s_cmp_eq_u32 s3, 7
    s_cbranch_scc1 L_w7
    s_call_b64 s[90:91], L_pub
    s_nop 1
L_w7:
    s_cmp_eq_u32 s5, 0
    s_cbranch_scc1 L_fin
    v_mul_u32_u24 v1, 48, v0
    s_mul_i32 s75, s54, 172032
    s_mul_i32 s57, s55, 3072
    s_add_u32 s75, s75, s57
    s_add_u32 s75, s75, 1048576
    buffer_load_dwordx4 v[64:67], v1, s[44:47], s75 offen offset:0 sc1
    buffer_load_dwordx4 v[68:71], v1, s[44:47], s75 offen offset:16 sc1
    buffer_load_dwordx4 v[72:75], v1, s[44:47], s75 offen offset:32 sc1
    v_mov_b32 v45, 1.0
    s_waitcnt vmcnt(3)
    s_call_b64 s[90:91], L_red_check
    s_nop 1
    v_mov_b32 v119, v126
    v_mov_b32 v123, v119
    s_nop 1
    v_permlane16_swap_b32 v119, v123
    v_max_f32 v119, v119, v123
    v_cvt_pk_bf16_f32 v116, v116, v116
    v_and_b32 v116, 0xffff0000, v116
    v_lshlrev_b32 v50, 16, v50
    v_mov_b32 v123, v119
    s_nop 1
    v_permlane32_swap_b32 v119, v123
    v_max_f32 v119, v119, v123
    v_add_f32 v116, v116, v50
    v_cvt_pk_bf16_f32 v116, v116, v116
    v_and_b32 v116, 0xffff0000, v116
    v_sub_f32 v126, v126, v119
    v_exp_f32 v126, v126
    v_mul_f32 v117, 0xbfb8aa3b, v116
    v_exp_f32 v117, v117
    v_mov_b32 v119, v126
    v_mov_b32 v123, v119
    s_nop 1
    v_permlane16_swap_b32 v119, v123
    v_add_f32 v119, v119, v123
    v_add_f32 v117, 1.0, v117
    v_rcp_f32 v117, v117
    v_mov_b32 v123, v119
    s_nop 1
    v_permlane32_swap_b32 v119, v123
    v_add_f32 v119, v119, v123
    v_mul_f32 v48, v116, v117
    v_cvt_pk_bf16_f32 v48, v48, v48
    v_and_b32 v48, 0xffff0000, v48
    v_lshlrev_b32 v49, 16, v49
    v_rcp_f32 v119, v119
    s_nop 0
    v_mul_f32 v45, v126, v119
    s_mov_b32 s73, s75
    v_mov_b32 v52, v1
    s_waitcnt vmcnt(0)
    v_mov_b32 v116, v64
    v_mov_b32 v117, v65
    v_mov_b32 v118, v66
    v_mov_b32 v119, v67
    v_mov_b32 v120, v68
    v_mov_b32 v121, v69
    v_mov_b32 v122, v70
    v_mov_b32 v123, v71
    v_mov_b32 v124, v72
    v_mov_b32 v125, v73
    v_mov_b32 v126, v74
    v_mov_b32 v127, v75
    s_call_b64 s[90:91], L_red_check
    s_nop 1
    v_cvt_pk_bf16_f32 v116, v116, v116
    v_and_b32 v116, 0xffff0000, v116
    v_mul_f32 v116, v116, v48
    v_cvt_pk_bf16_f32 v116, v116, v116
    v_and_b32 v116, 0xffff0000, v116
    v_add_f32 v116, v116, v49
    v_cvt_pk_bf16_f32 v116, v116, v116
    s_mov_b32 exec_lo, 0x01010101
    s_mov_b32 exec_hi, 0x01010101
    buffer_store_short v116, v5, s[48:51], 0 offen sc1
    s_cmp_lg_u32 s55, 0
    s_cbranch_scc1 L_fin
    s_mov_b64 exec, 1
    v_mov_b32 v117, s62
    s_lshl_b32 s57, s54, 8
    v_mov_b32 v118, s57
    buffer_store_dword v117, v118, s[44:47], 0 offen sc1
L_fin:
L_end:
    s_endpgm
L_pub:
    ds_read_b32 v24, v11 offset:12544
    ds_read_b32 v25, v11 offset:14592
    ds_read_b32 v26, v11 offset:16640
    ds_read_b32 v27, v11 offset:18688
    ds_read_b32 v28, v11 offset:20736
    ds_read_b32 v29, v11 offset:22784
    ds_read_b32 v30, v11 offset:24832
    ds_read_b32 v31, v11 offset:26880
    v_mov_b32 v39, s62
    s_waitcnt lgkmcnt(0)
    v_add_f32 v24, v24, v28
    v_add_f32 v25, v25, v29
    v_add_f32 v26, v26, v30
    v_add_f32 v27, v27, v31
    v_add_f32 v24, v24, v25
    v_add_f32 v26, v26, v27
    v_add_f32 v36, v24, v26
    s_nop 1
    v_mov_b32_dpp v37, v36 row_shl:1 row_mask:0xf bank_mask:0xf
    v_mov_b32_dpp v38, v36 row_shl:2 row_mask:0xf bank_mask:0xf
    v_cndmask_b32 v38, v38, v46, s[70:71]
    s_mov_b64 exec, s[64:65]
    buffer_store_dwordx4 v[36:39], v44, s[44:47], s63 offen sc1
    s_mov_b64 exec, -1
L_proj_ret:
    s_setpc_b64 s[90:91]
L_red_check:
    s_mov_b32 s74, 0
L_red_loop:
    v_cmp_ne_u32 s[76:77], s62, v119
    v_cmp_ne_u32 s[78:79], s62, v123
    v_cmp_ne_u32 s[80:81], s62, v127
    s_or_b64 s[76:77], s[76:77], s[78:79]
    s_or_b64 s[76:77], s[76:77], s[80:81]
    s_cbranch_scc0 L_red_done
    s_mov_b64 exec, s[76:77]
    buffer_load_dwordx4 v[116:119], v52, s[44:47], s73 offen offset:0 sc1
    buffer_load_dwordx4 v[120:123], v52, s[44:47], s73 offen offset:16 sc1
    buffer_load_dwordx4 v[124:127], v52, s[44:47], s73 offen offset:32 sc1
    s_add_u32 s74, s74, 1
    s_cmp_lt_u32 s74, 0x400000
    s_waitcnt vmcnt(0)
    s_cbranch_scc1 L_red_loop
L_red_done:
    s_mov_b64 exec, -1
    v_mul_f32 v116, v116, v45
    v_mul_f32 v117, v117, v45
    v_mul_f32 v118, v118, v45
    v_mul_f32 v120, v120, v45
    v_mul_f32 v121, v121, v45
    v_mul_f32 v122, v122, v45
    v_mul_f32 v124, v124, v45
    v_mul_f32 v125, v125, v45
L_red_tree:
    s_nop 0
    v_permlane32_swap_b32 v116, v117
    v_permlane32_swap_b32 v118, v120
    v_permlane32_swap_b32 v121, v122
    v_permlane32_swap_b32 v124, v125
    v_add_f32 v116, v116, v117
    v_add_f32 v118, v118, v120
    v_add_f32 v121, v121, v122
    v_add_f32 v124, v124, v125
    v_permlane16_swap_b32 v116, v118
    s_nop 0
    v_permlane16_swap_b32 v121, v124
    v_add_f32 v116, v116, v118
    v_add_f32 v121, v121, v124
    s_nop 0
    v_add_f32_dpp v116, v116, v116 row_ror:8 row_mask:0xf bank_mask:0x3
    s_nop 1
    v_add_f32_dpp v116, v121, v121 row_ror:8 row_mask:0xf bank_mask:0xc
    s_nop 1
    v_add_f32_dpp v116, v116, v116 row_half_mirror row_mask:0xf bank_mask:0xf
    s_nop 1
    v_add_f32_dpp v116, v116, v116 quad_perm:[2,3,0,1] row_mask:0xf bank_mask:0xf
    s_nop 1
    v_add_f32_dpp v116, v116, v116 quad_perm:[1,0,3,2] row_mask:0xf bank_mask:0xf
    s_setpc_b64 s[90:91]
.section .rodata,"a"
.p2align 6
.amdhsa_kernel recurrent_scan__mha_block_cached__dense_activation_squared_relu__decode_kernel
  .amdhsa_next_free_vgpr 256
  .amdhsa_next_free_sgpr 102
  .amdhsa_accum_offset 256
  .amdhsa_group_segment_fixed_size 0
  .amdhsa_kernarg_size 104
  .amdhsa_user_sgpr_count 2
  .amdhsa_user_sgpr_kernarg_segment_ptr 1
  .amdhsa_system_sgpr_workgroup_id_x 1
.end_amdhsa_kernel
```
